```python
import torch

def _softmax(x, axis=-1):
    return torch.softmax(x, dim=axis)
def _gelu(x):
    return torch.nn.functional.gelu(x, approximate="tanh")
def _silu(x):
    return torch.nn.functional.silu(x)
def _sigmoid(x):
    return torch.sigmoid(x)
def _layernorm(x, axis=-1, eps=1e-5):
    m = x.mean(dim=axis, keepdim=True)
    v = x.var(dim=axis, keepdim=True, unbiased=False)
    return (x - m) / torch.sqrt(v + eps)
def _scatter_add(tgt, idx, src, axis=0):
    return tgt.clone().index_add_(axis, idx, src)
def _segment_sum(src, seg, n):
    out = torch.zeros((n,) + src.shape[1:], dtype=src.dtype)
    return out.index_add_(0, seg, src)
def _pad(x, pw):
    flat = tuple(v for pair in reversed(pw) for v in pair)
    return torch.nn.functional.pad(x, flat)

kernel_name = 'standalone__hybrid_graph_tf_nagphormer__graph'

def setup_inputs():

    _w = (lambda a: (lambda t: t.to(torch.bfloat16) if t.is_floating_point() else t)(torch.as_tensor(a)))
    N, deg, D = 50000, 16, 64
    E = N * deg
    src = (lambda lo, hi, *s: torch.randint(lo, hi, s))(0, N, E).to(torch.int64)
    dst = (lambda lo, hi, *s: torch.randint(lo, hi, s))(0, N, E).to(torch.int64)
    deg_cnt = torch.bincount(dst, minlength=N).to(float) + 1.0
    sc = 1.0 / D ** 0.5
    return {
        "x": _w((lambda *s: torch.randn(*s, dtype=torch.bfloat16) * 0.1)(N, D)),
        "src": _w(src),
        "dst": _w(dst),
        "deg_inv_sqrt": _w(1.0 / (lambda _x: torch.sqrt(torch.as_tensor(_x)))(deg_cnt)),
        "wq": _w((lambda *s: torch.randn(*s, dtype=torch.bfloat16) * 3.2)(D, D) * sc),
        "wk": _w((lambda *s: torch.randn(*s, dtype=torch.bfloat16) * 3.2)(D, D) * sc),
        "wv": _w((lambda *s: torch.randn(*s, dtype=torch.bfloat16) * 0.1)(D, D) * sc),
        "wo": _w((lambda *s: torch.randn(*s, dtype=torch.bfloat16) * 0.1)(D, D) * sc),
        "w_r": _w((lambda *s: torch.randn(*s, dtype=torch.bfloat16) * 0.1)(D)),
    }

def reference(x, src, dst, deg_inv_sqrt, wq, wk, wv, wo, w_r):
    N, D = x.shape[0], x.shape[1]
    K = 7
    h = x
    toks = [x]
    for _ in range(K):
        msg = h[src] * deg_inv_sqrt[src, None] * deg_inv_sqrt[dst, None]
        h = _segment_sum(msg, dst, N)
        toks.append(h)
    tok = torch.stack(toks, axis=1)
    t = _layernorm(tok, axis=-1)
    q   = torch.einsum('nkd,de->nke', t, wq)
    key = torch.einsum('nkd,de->nke', t, wk)
    v   = torch.einsum('nkd,de->nke', t, wv)
    scale = 1.0 / (D ** 0.5)
    attn = _softmax(torch.einsum('nkd,nld->nkl', q, key) * scale, axis=-1)
    o = torch.einsum('nkl,nld->nkd', attn, v)
    o = tok + torch.einsum('nkd,de->nke', o, wo)
    r = _layernorm(o, axis=-1)
    alpha = _softmax(torch.einsum('nkd,d->nk', r, w_r), axis=-1)
    return torch.einsum('nk,nkd->nd', alpha, o)
```

```asm
; @launch grid=(256,1,1) block=(1024,1,1) lds=163840
.amdgcn_target "amdgcn-amd-amdhsa--gfx950"
.text
.globl standalone__hybrid_graph_tf_nagphormer__graph_kernel
.p2align 8
.type standalone__hybrid_graph_tf_nagphormer__graph_kernel,@function
standalone__hybrid_graph_tf_nagphormer__graph_kernel:
  s_cmp_ge_u32 s2, 256
  s_cbranch_scc1 L_end
  s_load_dwordx16 s[4:19], s[0:1], 0
  s_load_dwordx8 s[20:27], s[0:1], 64
  v_lshrrev_b32 v1, 6, v0
  v_and_b32 v68, 63, v0
  v_readfirstlane_b32 s3, v1
  v_lshlrev_b32 v2, 4, v0
  s_mul_i32 s56, s2, 12500
  s_mov_b32 s42, 3200000
  s_mov_b32 s43, 0x20000
  s_mov_b32 s46, 3200000
  s_mov_b32 s47, 0x20000
  s_cmp_ge_u32 s3, 13
  s_cbranch_scc1 L_pf
  s_and_b32 s89, s2, 7
  s_lshl_b32 s89, s89, 5
  s_lshr_b32 s57, s2, 3
  s_add_u32 s89, s89, s57
  s_mov_b32 s62, 0
  s_mul_i32 s52, s3, 8960
  s_mul_i32 s58, s89, 96
  s_mul_i32 s59, s89, 100
  s_add_u32 s59, s59, 24560
  s_cmp_lt_u32 s3, 8
  s_cselect_b32 s49, s58, s59
  s_lshl_b32 s57, s3, 1
  s_add_u32 s49, s49, s57
  s_and_b32 s57, s3, 14
  s_cmp_eq_u32 s57, 8
  s_cselect_b32 s88, 48, 32
  v_and_b32 v28, 48, v68
  v_bfe_u32 v29, v68, 3, 1
  v_add3_u32 v28, v28, v29, s49
  v_cmp_gt_u32 vcc, s88, v68
  v_add_u32 v29, 64, v28
  v_mov_b32 v19, 0x01000000
  v_cndmask_b32 v29, v19, v29, vcc
  v_and_b32 v19, 0x70, v2
  v_lshl_add_u32 v80, v28, 7, v19
  v_lshl_add_u32 v81, v29, 7, v19
  v_lshlrev_b32 v24, 1, v28
  v_lshlrev_b32 v25, 1, v29
  s_waitcnt lgkmcnt(0)
  s_mov_b64 s[44:45], s[8:9]
  s_mov_b64 s[40:41], s[6:7]
  buffer_load_dwordx4 v[4:7], v2, s[44:47], s56 offen
  buffer_load_dwordx4 v[8:11], v2, s[40:43], s56 offen
  s_branch L_nopf
L_pf:
  s_and_b32 s89, s2, 7
  s_lshl_b32 s89, s89, 5
  s_lshr_b32 s57, s2, 3
  s_add_u32 s89, s89, s57
  s_mov_b32 s62, 0
  s_mul_i32 s52, s3, 8960
  s_mul_i32 s58, s89, 96
  s_mul_i32 s59, s89, 100
  s_add_u32 s59, s59, 24560
  s_cmp_lt_u32 s3, 8
  s_cselect_b32 s49, s58, s59
  s_lshl_b32 s57, s3, 1
  s_add_u32 s49, s49, s57
  s_and_b32 s57, s3, 14
  s_cmp_eq_u32 s57, 8
  s_cselect_b32 s88, 48, 32
  v_and_b32 v28, 48, v68
  v_bfe_u32 v29, v68, 3, 1
  v_add3_u32 v28, v28, v29, s49
  v_cmp_gt_u32 vcc, s88, v68
  v_add_u32 v29, 64, v28
  v_mov_b32 v19, 0x01000000
  v_cndmask_b32 v29, v19, v29, vcc
  v_and_b32 v19, 0x70, v2
  v_lshl_add_u32 v80, v28, 7, v19
  v_lshl_add_u32 v81, v29, 7, v19
  v_lshlrev_b32 v24, 1, v28
  v_lshlrev_b32 v25, 1, v29
  s_cmp_lg_u32 s3, 13
  s_cbranch_scc1 L_pfe
  s_getpc_b64 s[94:95]
L_pc1:
  v_lshlrev_b32 v8, 7, v68
  global_load_dword v4, v8, s[94:95]
  v_add_u32 v8, 8192, v8
  global_load_dword v5, v8, s[94:95]
  v_add_u32 v8, 8192, v8
  v_min_u32 v6, lane_table+2044-L_pc1, v8
  global_load_dword v6, v6, s[94:95]
  v_add_u32 v8, 8192, v8
  v_min_u32 v8, lane_table+2044-L_pc1, v8
  global_load_dword v7, v8, s[94:95]
L_pfe:
L_nopf:
  v_mov_b32 v16, 0
  v_lshlrev_b32 v3, 2, v0
  s_cmp_ge_u32 s3, 4
  s_cbranch_scc1 L_noedge
  v_add_u32 v22, 156672, v3
  ds_write_b32 v22, v16
  ds_write_b32 v22, v16 offset:3072
  ds_write_b32 v16, v16 offset:7904
  ds_write_b32 v16, v16 offset:7908
  ds_write_b32 v16, v16 offset:7912
  ds_write_b32 v16, v16 offset:7916
L_noedge:
  s_waitcnt lgkmcnt(0)
  s_add_u32 s26, s26, 0x1fffff
  s_addc_u32 s27, s27, 0
  s_and_b32 s26, s26, 0xffe00000
  s_add_u32 s36, s26, 117440512
  s_addc_u32 s37, s27, 0
  s_mov_b32 s38, 8388608
  s_mov_b32 s39, 0x20000
  s_mov_b32 s96, s24
  s_mov_b32 s97, s25
  s_mov_b32 s98, 256
  s_mov_b32 s99, 0x20000
  s_mov_b32 s40, s4
  s_mov_b32 s41, s5
  s_mov_b32 s42, 6400000
  s_mov_b32 s43, 0x20000
  s_mov_b32 s44, s10
  s_mov_b32 s45, s11
  s_mov_b32 s46, 100000
  s_mov_b32 s47, 0x20000
  s_cmp_lg_u32 s3, 15
  s_cbranch_scc1 L_b1
  buffer_load_dword v4, v16, s[96:99], 0 offen offset:128 sc1
  s_cmp_gt_u32 s2, 32
  s_cbranch_scc1 L_b1
  v_lshlrev_b32 v6, 4, v68
  v_mov_b32 v8, 0
  v_mov_b32 v9, 0
  v_mov_b32 v10, 0
  v_mov_b32 v11, 0
  s_lshl_b32 s56, s2, 10
  s_add_u32 s56, s56, 5274624
  s_cmp_eq_u32 s2, 0
  s_cselect_b32 s56, 5259264, s56
  buffer_store_dwordx4 v[8:11], v6, s[36:39], s56 offen sc1
  s_cbranch_scc0 L_b1
  s_mov_b32 s56, 5267456
  buffer_store_dwordx4 v[8:11], v6, s[36:39], s56 offen offset:0 sc1
  buffer_store_dwordx4 v[8:11], v6, s[36:39], s56 offen offset:1024 sc1
  buffer_store_dwordx4 v[8:11], v6, s[36:39], s56 offen offset:2048 sc1
  buffer_store_dwordx4 v[8:11], v6, s[36:39], s56 offen offset:3072 sc1
  s_mov_b32 s56, 5271552
  buffer_store_dwordx4 v[8:11], v6, s[36:39], s56 offen offset:0 sc1
  buffer_store_dwordx4 v[8:11], v6, s[36:39], s56 offen offset:1024 sc1
  buffer_store_dwordx4 v[8:11], v6, s[36:39], s56 offen offset:2048 sc1
  buffer_store_dwordx4 v[8:11], v6, s[36:39], s56 offen offset:3072 sc1
L_b1:
  s_waitcnt lgkmcnt(0)
  s_barrier
  s_cmp_lg_u32 s3, 15
  s_cbranch_scc1 L_xl
  s_cmp_lg_u32 s2, 0
  s_cbranch_scc1 L_xl
  s_waitcnt vmcnt(0)
  v_mov_b32 v6, 1
  s_mov_b64 exec, 1
  buffer_store_dword v6, v16, s[96:99], 0 offen sc1
  s_mov_b64 exec, -1
L_xl:
  s_cmp_lt_u32 s3, 13
  s_cbranch_scc1 L_xm
  buffer_load_dwordx4 v[44:47], v80, s[40:43], 0 offen
  buffer_load_dwordx4 v[48:51], v81, s[40:43], 0 offen
  buffer_load_ushort v26, v24, s[44:47], 0 offen
  buffer_load_ushort v27, v25, s[44:47], 0 offen
L_xm:
  v_mov_b32 v62, v0
  s_add_u32 s90, s26, 14680064
  s_addc_u32 s91, s27, 0
  s_add_u32 s92, s26, 122683392
  s_addc_u32 s93, s27, 0
  s_mov_b32 s63, 0
  s_mov_b32 s53, 0
  s_getreg_b32 s77, hwreg(HW_REG_XCC_ID, 0, 3)
  s_lshl_b32 s77, s77, 7
  s_add_u32 s77, s77, 16384
  s_mov_b32 s28, s26
  s_mov_b32 s29, s27
  s_mov_b32 s30, 13631488
  s_mov_b32 s31, 0x20000
  s_mov_b32 s32, s26
  s_mov_b32 s33, s27
  s_mov_b32 s34, 13631488
  s_mov_b32 s35, 0x20000
  s_cmp_lt_u32 s3, 13
  s_cbranch_scc1 L_p1
  s_cmp_eq_u32 s3, 13
  s_cbranch_scc1 L_p1_b2
  s_cmp_eq_u32 s3, 15
  s_cbranch_scc1 L_w15
  s_lshr_b32 s86, s2, 6
  s_lshl_b32 s86, s86, 14
  s_and_b32 s57, s2, 63
  s_lshl_b32 s57, s57, 7
  s_add_u32 s86, s86, s57
  s_and_b32 s57, s2, 8
  s_lshl_b32 s57, s57, 10
  s_add_u32 s86, s86, s57
  s_xor_b32 s57, s86, 0x2000
  s_mov_b32 s58, 1
  s_mov_b32 s59, 1
  s_atomic_add s58, s[90:91], s86 glc
  s_atomic_add s59, s[90:91], s57 glc
L_w15:
  v_and_b32 v12, 15, v68
  v_lshrrev_b32 v13, 4, v68
  v_mov_b32 v20, 0xffff80
  v_mov_b32 v21, 0xffff80
  v_mov_b32 v22, 0xffff80
  v_mov_b32 v23, 0xffff80
  v_lshl_add_u32 v17, v68, 4, s52
  ds_write_b128 v17, v[20:23] offset:6144
  ds_write_b128 v17, v[20:23] offset:6528
  v_bfe_u32 v16, v68, 2, 1
  v_bfe_u32 v14, v68, 3, 1
  v_lshl_add_u32 v16, v13, 1, v16
  v_lshl_add_u32 v16, v16, 7, s52
  v_lshl_add_u32 v16, v14, 10, v16
  v_and_b32 v18, 1, v13
  v_lshl_add_u32 v17, v18, 1, v14
  v_lshl_add_u32 v16, v17, 5, v16
  v_and_b32 v17, 3, v68
  v_lshl_add_u32 v32, v17, 3, v16
  v_xor_b32 v33, 32, v32
  v_xor_b32 v34, 64, v32
  v_xor_b32 v35, 96, v32
  v_and_b32 v16, 7, v68
  v_lshlrev_b32 v18, 2, v18
  v_xor_b32 v17, v18, v16
  v_lshlrev_b32 v36, 4, v17
  v_xor_b32 v37, 32, v36
  s_mov_b32 s56, 0x01010101
  v_mul_lo_u32 v40, v12, s56
  v_not_b32 v40, v40
  s_mov_b32 s60, 0x40404041
  s_mov_b32 s61, 0x40004000
  s_mov_b32 s7, 0xffff80
  s_movk_i32 s56, 144
  v_lshl_add_u32 v17, v13, 3, s52
  v_mad_u32_u24 v66, v12, s56, v17
  v_cmp_gt_u32 vcc, 14, v12
  v_mov_b32 v17, 2147483648
  v_lshrrev_b32 v18, 3, v68
  v_cndmask_b32 v66, v17, v66, vcc
  v_lshl_add_u32 v17, v16, 4, s52
  v_mad_u32_u24 v67, v18, s56, v17
  v_lshl_add_u32 v17, v13, 4, s52
  v_mad_u32_u24 v64, v14, s56, v17
  v_lshl_add_u32 v65, v12, 6, s52
  v_mov_b32 v63, 1.0
  s_barrier
  s_barrier
  s_barrier
  s_cmp_eq_u32 s3, 14
  s_cbranch_scc1 L_w15q
  v_mov_b32 v16, 0
L_w15p:
  buffer_load_dword v17, v16, s[96:99], 0 offen sc1
  s_waitcnt vmcnt(0)
  v_readfirstlane_b32 s56, v17
  s_nop 0
  s_cmp_lg_u32 s56, 0
  s_cbranch_scc1 L_w15o
  s_add_u32 s62, s62, 1
  s_cmp_lt_u32 s62, 16777216
  s_cbranch_scc1 L_w15p
  s_endpgm
L_w15o:
L_w15q:
  s_setprio 3
  v_and_b32 v19, 7, v68
  v_lshlrev_b32 v19, 4, v19
  v_and_b32 v24, 0xffc0, v28
  v_add_lshl_u32 v24, v24, v28, 7
  v_and_b32 v25, 0x2000, v28
  v_or3_b32 v42, v24, v25, v19
  v_xor_b32 v30, 0x2000, v42
  v_and_b32 v24, 0xffc0, v29
  v_add_lshl_u32 v24, v24, v29, 7
  v_and_b32 v25, 0x2000, v29
  v_or3_b32 v43, v24, v25, v19
  v_xor_b32 v31, 0x2000, v43
  s_waitcnt vmcnt(0)
  v_lshlrev_b32 v26, 16, v26
  v_lshlrev_b32 v24, 16, v44
  v_and_b32 v25, 0xffff0000, v44
  v_mul_f32 v24, v24, v26
  v_mul_f32 v25, v25, v26
  v_cvt_pk_bf16_f32 v72, v24, v25
  v_lshlrev_b32 v24, 16, v45
  v_and_b32 v25, 0xffff0000, v45
  v_mul_f32 v24, v24, v26
  v_mul_f32 v25, v25, v26
  v_cvt_pk_bf16_f32 v73, v24, v25
  v_lshlrev_b32 v24, 16, v46
  v_and_b32 v25, 0xffff0000, v46
  v_mul_f32 v24, v24, v26
  v_mul_f32 v25, v25, v26
  v_cvt_pk_bf16_f32 v74, v24, v25
  v_lshlrev_b32 v24, 16, v47
  v_and_b32 v25, 0xffff0000, v47
  v_mul_f32 v24, v24, v26
  v_mul_f32 v25, v25, v26
  v_cvt_pk_bf16_f32 v75, v24, v25
  v_lshlrev_b32 v27, 16, v27
  v_lshlrev_b32 v24, 16, v48
  v_and_b32 v25, 0xffff0000, v48
  v_mul_f32 v24, v24, v27
  v_mul_f32 v25, v25, v27
  v_cvt_pk_bf16_f32 v76, v24, v25
  v_lshlrev_b32 v24, 16, v49
  v_and_b32 v25, 0xffff0000, v49
  v_mul_f32 v24, v24, v27
  v_mul_f32 v25, v25, v27
  v_cvt_pk_bf16_f32 v77, v24, v25
  v_lshlrev_b32 v24, 16, v50
  v_and_b32 v25, 0xffff0000, v50
  v_mul_f32 v24, v24, v27
  v_mul_f32 v25, v25, v27
  v_cvt_pk_bf16_f32 v78, v24, v25
  v_lshlrev_b32 v24, 16, v51
  v_and_b32 v25, 0xffff0000, v51
  v_mul_f32 v24, v24, v27
  v_mul_f32 v25, v25, v27
  v_cvt_pk_bf16_f32 v79, v24, v25
  s_barrier
  s_cmp_eq_u32 s3, 14
  s_cbranch_scc1 L_w14
  s_lshr_b32 s57, s2, 2
  s_lshl_b32 s57, s57, 7
  s_add_u32 s57, s57, 24576
  s_mov_b32 s68, 1
  s_atomic_add s68, s[92:93], s57
  s_setprio 3
L_w14:
  ds_write_b128 v67, v[44:47]
  ds_write_b128 v67, v[48:51] offset:1152
  v_lshrrev_b32 v16, 3, v68
  v_lshl_add_u32 v16, v16, 2, s52
  ds_write_b32 v16, v26 offset:2304
  ds_write_b32 v16, v27 offset:2336
  v_and_b32 v17, 15, v68
  v_lshl_add_u32 v17, v17, 2, s52
  ds_read_b64 v[44:45], v66 offset:0
  ds_read_b64 v[46:47], v66 offset:32
  ds_read_b64 v[48:49], v66 offset:64
  ds_read_b64 v[50:51], v66 offset:96
  ds_read_b32 v41, v17 offset:2304
  s_waitcnt lgkmcnt(0)
  v_lshlrev_b32 v0, 16, v44
  v_and_b32 v1, 0xffff0000, v44
  v_lshlrev_b32 v2, 16, v45
  v_and_b32 v3, 0xffff0000, v45
  v_lshlrev_b32 v4, 16, v46
  v_and_b32 v5, 0xffff0000, v46
  v_lshlrev_b32 v6, 16, v47
  v_and_b32 v7, 0xffff0000, v47
  v_lshlrev_b32 v8, 16, v48
  v_and_b32 v9, 0xffff0000, v48
  v_lshlrev_b32 v10, 16, v49
  v_and_b32 v11, 0xffff0000, v49
  v_lshlrev_b32 v12, 16, v50
  v_and_b32 v13, 0xffff0000, v50
  v_lshlrev_b32 v14, 16, v51
  v_and_b32 v15, 0xffff0000, v51
  v_add_f32 v24, v0, v2
  v_add_f32 v25, v1, v3
  v_mul_f32 v48, v0, v0
  v_mul_f32 v49, v1, v1
  v_fmac_f32 v48, v2, v2
  v_fmac_f32 v49, v3, v3
  v_add_f32 v24, v24, v4
  v_fmac_f32 v48, v4, v4
  v_add_f32 v25, v25, v5
  v_fmac_f32 v49, v5, v5
  v_add_f32 v24, v24, v6
  v_fmac_f32 v48, v6, v6
  v_add_f32 v25, v25, v7
  v_fmac_f32 v49, v7, v7
  v_add_f32 v24, v24, v8
  v_fmac_f32 v48, v8, v8
  v_add_f32 v25, v25, v9
  v_fmac_f32 v49, v9, v9
  v_add_f32 v24, v24, v10
  v_fmac_f32 v48, v10, v10
  v_add_f32 v25, v25, v11
  v_fmac_f32 v49, v11, v11
  v_add_f32 v24, v24, v12
  v_fmac_f32 v48, v12, v12
  v_add_f32 v25, v25, v13
  v_fmac_f32 v49, v13, v13
  v_add_f32 v24, v24, v14
  v_fmac_f32 v48, v14, v14
  v_add_f32 v25, v25, v15
  v_fmac_f32 v49, v15, v15
  v_add_f32 v24, v24, v25
  v_add_f32 v48, v48, v49
  v_mul_f32 v49, v63, v63
  s_nop 0
  v_permlane16_swap_b32 v24, v48
  v_add_f32 v24, v24, v48
  v_mov_b32 v48, v24
  v_mov_b32 v50, 0x3727c5ac
  s_nop 0
  v_permlane32_swap_b32 v24, v48
  v_add_f32 v24, v24, v48
  v_mul_f32 v24, 0x3c800000, v24
  v_mov_b32 v48, v24
  s_lshl_b32 s56, s53, 3
  v_add_u32 v51, s56, v65
  v_permlane16_swap_b32 v24, v48
  v_fma_f32 v48, -v24, v24, v48
  v_max_f32 v48, 0, v48
  v_fmac_f32 v50, v49, v48
  v_rsq_f32 v49, v50
  v_mul_f32 v27, v24, v63
  v_mul_f32 v26, v50, v49
  v_mul_f32 v48, v49, v63
  v_mul_f32 v49, v49, v27
  ds_write_b64 v51, v[26:27] offset:7936
  v_fma_f32 v0, v48, v0, -v49
  v_fma_f32 v1, v48, v1, -v49
  v_fma_f32 v2, v48, v2, -v49
  v_fma_f32 v3, v48, v3, -v49
  v_cvt_pk_bf16_f32 v16, v0, v1
  v_cvt_pk_bf16_f32 v17, v2, v3
  ds_write_b64 v66, v[16:17] offset:4096
  v_fma_f32 v4, v48, v4, -v49
  v_fma_f32 v5, v48, v5, -v49
  v_fma_f32 v6, v48, v6, -v49
  v_fma_f32 v7, v48, v7, -v49
  v_cvt_pk_bf16_f32 v18, v4, v5
  v_cvt_pk_bf16_f32 v19, v6, v7
  ds_write_b64 v66, v[18:19] offset:4128
  v_fma_f32 v8, v48, v8, -v49
  v_fma_f32 v9, v48, v9, -v49
  v_fma_f32 v10, v48, v10, -v49
  v_fma_f32 v11, v48, v11, -v49
  v_cvt_pk_bf16_f32 v20, v8, v9
  v_cvt_pk_bf16_f32 v21, v10, v11
  ds_write_b64 v66, v[20:21] offset:4160
  v_fma_f32 v12, v48, v12, -v49
  v_fma_f32 v13, v48, v13, -v49
  v_fma_f32 v14, v48, v14, -v49
  v_fma_f32 v15, v48, v15, -v49
  v_cvt_pk_bf16_f32 v22, v12, v13
  v_cvt_pk_bf16_f32 v23, v14, v15
  ds_write_b64 v66, v[22:23] offset:4192
  s_lshl_b32 s11, 0x01010101, s53
  s_cmp_eq_u32 s3, 14
  s_cbranch_scc1 L_w14b
  s_mov_b32 s56, 5267456
  v_lshlrev_b32 v16, 7, v68
  s_mov_b32 exec_lo, 0xffffffff
  s_mov_b32 exec_hi, 0xffffffff
L_pl_2:
  buffer_load_dword v17, v16, s[36:39], s56 offen sc1
  s_waitcnt vmcnt(0)
  v_cmpx_gt_u32 vcc, 4, v17
  s_cbranch_execz L_pd_3
  s_bcnt1_i32_b64 s57, exec
  s_cmp_le_u32 s57, 32
  s_cbranch_scc1 L_pl_2_n
  s_mov_b64 s[64:65], exec
  s_ff1_i32_b64 s57, exec
  s_lshl_b64 exec, 1, s57
L_pl_2_o:
  buffer_load_dword v17, v16, s[36:39], s56 offen sc1
  s_waitcnt vmcnt(0)
  v_cmp_gt_u32 vcc, 4, v17
  s_cbranch_vccz L_pl_2_q
  s_add_u32 s62, s62, 1
  s_cmp_lt_u32 s62, 16777216
  s_cbranch_scc1 L_pl_2_o
  s_endpgm
L_pl_2_q:
  s_mov_b64 exec, s[64:65]
L_pl_2_n:
  s_add_u32 s62, s62, 1
  s_cmp_lt_u32 s62, 16777216
  s_cbranch_scc1 L_pl_2
  s_endpgm
L_pd_3:
  s_mov_b64 exec, -1
  s_branch L_w15s
L_w14b:
  s_waitcnt lgkmcnt(0)
  s_mov_b32 s58, 0
  s_mov_b32 s70, 0
  s_mov_b32 s87, 0
L_pr:
  s_mov_b32 s57, 1
  s_memtime s[66:67]
  s_waitcnt lgkmcnt(0)
  s_atomic_add s57, s[90:91], s86 glc
  s_waitcnt lgkmcnt(0)
  s_memtime s[68:69]
  s_waitcnt lgkmcnt(0)
  s_sub_u32 s57, s66, s68
  s_max_u32 s57, s70, s57
  s_mov_b32 s70, s87
  s_mov_b32 s87, s57
  s_xor_b32 s86, s86, 0x2000
  s_add_u32 s58, s58, 1
  s_cmp_lt_u32 s58, 1
  s_cbranch_scc1 L_pr
  s_lshr_b32 s56, s86, 11
  s_and_b32 s56, s56, 4
  s_add_u32 s56, s56, s77
  s_xor_b32 s57, s56, 4
  s_atomic_umax s87, s[92:93], s57 glc
L_w15s:
  s_setprio 0
  s_cmp_ge_u32 s3, 8
  s_cbranch_scc1 L_g0_4
  buffer_store_dwordx4 v[72:75], v42, s[32:35], 0 offen sc1
  buffer_store_dwordx4 v[72:75], v30, s[32:35], 0 offen sc1
  buffer_store_dwordx4 v[76:79], v43, s[32:35], 0 offen sc1
  buffer_store_dwordx4 v[76:79], v31, s[32:35], 0 offen sc1
L_g0_4:
  s_branch L_b5
L_p1:
  s_mov_b32 s56, 24576
  s_mov_b32 s57, 156672
  s_movk_i32 s59, 0x2000
  v_mov_b32 v2, 1
  v_mov_b32 v32, 21846
  v_mov_b32 v33, 20972
  v_mov_b32 v34, -96
  v_mov_b32 v35, -100
  v_mov_b32 v20, 0x10000000
  v_mov_b32 v21, 0x10000000
  v_mov_b32 v22, 0x10000000
  v_mov_b32 v23, 0x10000000
  s_waitcnt vmcnt(1)
  v_cmp_le_u32 s[64:65], s56, v4
  v_subrev_u32 v16, s56, v4
  v_min_u32 v4, v16, v4
  v_cndmask_b32 v16, v32, v33, s[64:65]
  v_mul_u32_u24 v16, v16, v4
  v_lshrrev_b32 v36, 21, v16
  v_lshl_add_u32 v12, v36, 2, s57
  v_cmp_le_u32 s[78:79], s56, v5
  v_subrev_u32 v16, s56, v5
  v_min_u32 v5, v16, v5
  v_cndmask_b32 v16, v32, v33, s[78:79]
  v_mul_u32_u24 v16, v16, v5
  v_lshrrev_b32 v37, 21, v16
  v_lshl_add_u32 v13, v37, 2, s57
  v_cmp_le_u32 s[66:67], s56, v6
  v_subrev_u32 v16, s56, v6
  v_min_u32 v6, v16, v6
  v_cndmask_b32 v16, v32, v33, s[66:67]
  v_mul_u32_u24 v16, v16, v6
  v_lshrrev_b32 v38, 21, v16
  v_lshl_add_u32 v14, v38, 2, s57
  v_cmp_le_u32 s[68:69], s56, v7
  v_subrev_u32 v16, s56, v7
  v_min_u32 v7, v16, v7
  v_cndmask_b32 v16, v32, v33, s[68:69]
  v_mul_u32_u24 v16, v16, v7
  v_lshrrev_b32 v39, 21, v16
  v_lshl_add_u32 v15, v39, 2, s57
  v_cmpx_gt_u32 vcc, 3125, v3
  ds_add_rtn_u32 v20, v12, v2
  v_cmpx_gt_u32 vcc, 3124, v3
  ds_add_rtn_u32 v21, v13, v2
  ds_add_rtn_u32 v22, v14, v2
  ds_add_rtn_u32 v23, v15, v2
  s_mov_b64 exec, -1
  buffer_load_dwordx4 v[44:47], v80, s[40:43], 0 offen
  buffer_load_dwordx4 v[48:51], v81, s[40:43], 0 offen
  buffer_load_ushort v26, v24, s[44:47], 0 offen
  buffer_load_ushort v27, v25, s[44:47], 0 offen
  v_cndmask_b32 v16, v34, v35, s[64:65]
  v_mad_i32_i24 v4, v36, v16, v4
  v_cndmask_b32 v16, 0, 8, s[64:65]
  v_lshrrev_b32 v17, 3, v4
  v_bfi_b32 v17, 1, v4, v17
  v_lshrrev_b32 v18, 1, v4
  v_bfi_b32 v18, 7, v18, v16
  v_lshl_or_b32 v4, v18, 28, v17
  v_cndmask_b32 v16, v34, v35, s[78:79]
  v_mad_i32_i24 v5, v37, v16, v5
  v_cndmask_b32 v16, 0, 8, s[78:79]
  v_lshrrev_b32 v17, 3, v5
  v_bfi_b32 v17, 1, v5, v17
  v_lshrrev_b32 v18, 1, v5
  v_bfi_b32 v18, 7, v18, v16
  v_lshl_or_b32 v5, v18, 28, v17
  v_cndmask_b32 v16, v34, v35, s[66:67]
  v_mad_i32_i24 v6, v38, v16, v6
  v_cndmask_b32 v16, 0, 8, s[66:67]
  v_lshrrev_b32 v17, 3, v6
  v_bfi_b32 v17, 1, v6, v17
  v_lshrrev_b32 v18, 1, v6
  v_bfi_b32 v18, 7, v18, v16
  v_lshl_or_b32 v6, v18, 28, v17
  v_cndmask_b32 v16, v34, v35, s[68:69]
  v_mad_i32_i24 v7, v39, v16, v7
  v_cndmask_b32 v16, 0, 8, s[68:69]
  v_lshrrev_b32 v17, 3, v7
  v_bfi_b32 v17, 1, v7, v17
  v_lshrrev_b32 v18, 1, v7
  v_bfi_b32 v18, 7, v18, v16
  v_lshl_or_b32 v7, v18, 28, v17
  s_waitcnt lgkmcnt(0)
  s_barrier
  s_waitcnt vmcnt(4)
  v_and_b32 v16, 0xffc0, v8
  v_add_lshl_u32 v16, v16, v8, 7
  v_and_or_b32 v16, v8, s59, v16
  v_lshrrev_b32 v17, 12, v8
  v_lshl_or_b32 v16, v17, 24, v16
  v_or_b32 v8, v16, v4
  v_and_b32 v16, 0xffc0, v9
  v_add_lshl_u32 v16, v16, v9, 7
  v_and_or_b32 v16, v9, s59, v16
  v_lshrrev_b32 v17, 12, v9
  v_lshl_or_b32 v16, v17, 24, v16
  v_or_b32 v9, v16, v5
  v_and_b32 v16, 0xffc0, v10
  v_add_lshl_u32 v16, v16, v10, 7
  v_and_or_b32 v16, v10, s59, v16
  v_lshrrev_b32 v17, 12, v10
  v_lshl_or_b32 v16, v17, 24, v16
  v_or_b32 v10, v16, v6
  v_and_b32 v16, 0xffc0, v11
  v_add_lshl_u32 v16, v16, v11, 7
  v_and_or_b32 v16, v11, s59, v16
  v_lshrrev_b32 v17, 12, v11
  v_lshl_or_b32 v16, v17, 24, v16
  v_or_b32 v11, v16, v7
  s_barrier
  s_branch L_p1_sc
L_p1_b2:
  s_setprio 3
  s_barrier
  v_lshlrev_b32 v61, 4, v68
  v_add_u32 v61, 156672, v61
  ds_read_b128 v[52:55], v61
  s_waitcnt lgkmcnt(0)
  v_add_u32 v58, v52, v53
  v_add_u32 v59, v58, v54
  v_add_u32 v56, v59, v55
  v_mov_b32 v60, v56
  s_nop 1
  v_add_u32_dpp v60, v60, v60 row_shr:1 row_mask:0xf bank_mask:0xf
  s_nop 1
  v_add_u32_dpp v60, v60, v60 row_shr:2 row_mask:0xf bank_mask:0xf
  s_nop 1
  v_add_u32_dpp v60, v60, v60 row_shr:4 row_mask:0xf bank_mask:0xf
  s_nop 1
  v_add_u32_dpp v60, v60, v60 row_shr:8 row_mask:0xf bank_mask:0xf
  s_nop 1
  v_add_u32_dpp v60, v60, v60 row_bcast:15 row_mask:0xa bank_mask:0xf
  s_nop 1
  v_add_u32_dpp v60, v60, v60 row_bcast:31 row_mask:0xc bank_mask:0xf
  v_sub_u32 v56, v60, v56
  v_add_u32 v56, 35840, v56
  v_add_u32 v57, v56, v52
  v_add_u32 v58, v56, v58
  v_add_u32 v59, v56, v59
  ds_write_b128 v61, v[56:59] offset:1024
  s_waitcnt lgkmcnt(0)
  s_barrier
  s_setprio 0
  v_subrev_u32 v56, 35840, v56
  v_lshl_or_b32 v52, v52, 16, v56
  v_subrev_u32 v57, 35840, v57
  v_lshl_or_b32 v53, v53, 16, v57
  v_subrev_u32 v58, 35840, v58
  v_lshl_or_b32 v54, v54, 16, v58
  v_subrev_u32 v59, 35840, v59
  v_lshl_or_b32 v55, v55, 16, v59
  s_lshl_b32 s56, s2, 10
  s_add_u32 s56, s56, 4194304
  v_lshlrev_b32 v16, 4, v68
  buffer_store_dwordx4 v[52:55], v16, s[36:39], s56 offen sc1
  s_barrier
  s_branch L_p1_g
L_p1_sc:
  ds_read_b32 v16, v12 offset:1024
  ds_read_b32 v17, v13 offset:1024
  ds_read_b32 v18, v14 offset:1024
  ds_read_b32 v19, v15 offset:1024
  v_lshlrev_b32 v2, 4, v0
  v_add_u32 v3, 143360, v2
  s_mul_i32 s56, s2, 12544
  v_cmp_gt_u32 vcc, 12544, v2
  v_mov_b32 v1, 2147483648
  s_nop 0
  v_cndmask_b32 v2, v1, v2, vcc
  s_waitcnt lgkmcnt(3)
  v_add_lshl_u32 v16, v16, v20, 2
  ds_write_b32 v16, v8
  s_waitcnt lgkmcnt(3)
  v_add_lshl_u32 v17, v17, v21, 2
  ds_write_b32 v17, v9
  s_waitcnt lgkmcnt(3)
  v_add_lshl_u32 v18, v18, v22, 2
  ds_write_b32 v18, v10
  s_waitcnt lgkmcnt(3)
  v_add_lshl_u32 v19, v19, v23, 2
  ds_write_b32 v19, v11
  s_waitcnt lgkmcnt(0)
  s_barrier
  ds_read_b128 v[4:7], v3
  s_waitcnt lgkmcnt(0)
  buffer_store_dwordx4 v[4:7], v2, s[36:39], s56 offen sc1
L_p1_g:
  v_and_b32 v19, 7, v68
  v_lshlrev_b32 v19, 4, v19
  v_and_b32 v24, 0xffc0, v28
  v_add_lshl_u32 v24, v24, v28, 7
  v_and_b32 v25, 0x2000, v28
  v_or3_b32 v42, v24, v25, v19
  v_xor_b32 v30, 0x2000, v42
  v_and_b32 v24, 0xffc0, v29
  v_add_lshl_u32 v24, v24, v29, 7
  v_and_b32 v25, 0x2000, v29
  v_or3_b32 v43, v24, v25, v19
  v_xor_b32 v31, 0x2000, v43
  s_waitcnt vmcnt(1)
  v_lshlrev_b32 v26, 16, v26
  v_lshlrev_b32 v24, 16, v44
  v_and_b32 v25, 0xffff0000, v44
  v_mul_f32 v24, v24, v26
  v_mul_f32 v25, v25, v26
  v_cvt_pk_bf16_f32 v72, v24, v25
  v_lshlrev_b32 v24, 16, v45
  v_and_b32 v25, 0xffff0000, v45
  v_mul_f32 v24, v24, v26
  v_mul_f32 v25, v25, v26
  v_cvt_pk_bf16_f32 v73, v24, v25
  v_lshlrev_b32 v24, 16, v46
  v_and_b32 v25, 0xffff0000, v46
  v_mul_f32 v24, v24, v26
  v_mul_f32 v25, v25, v26
  v_cvt_pk_bf16_f32 v74, v24, v25
  v_lshlrev_b32 v24, 16, v47
  v_and_b32 v25, 0xffff0000, v47
  v_mul_f32 v24, v24, v26
  v_mul_f32 v25, v25, v26
  v_cvt_pk_bf16_f32 v75, v24, v25
  v_lshlrev_b32 v27, 16, v27
  v_lshlrev_b32 v24, 16, v48
  v_and_b32 v25, 0xffff0000, v48
  v_mul_f32 v24, v24, v27
  v_mul_f32 v25, v25, v27
  v_cvt_pk_bf16_f32 v76, v24, v25
  v_lshlrev_b32 v24, 16, v49
  v_and_b32 v25, 0xffff0000, v49
  v_mul_f32 v24, v24, v27
  v_mul_f32 v25, v25, v27
  v_cvt_pk_bf16_f32 v77, v24, v25
  v_lshlrev_b32 v24, 16, v50
  v_and_b32 v25, 0xffff0000, v50
  v_mul_f32 v24, v24, v27
  v_mul_f32 v25, v25, v27
  v_cvt_pk_bf16_f32 v78, v24, v25
  v_lshlrev_b32 v24, 16, v51
  v_and_b32 v25, 0xffff0000, v51
  v_mul_f32 v24, v24, v27
  v_mul_f32 v25, v25, v27
  v_cvt_pk_bf16_f32 v79, v24, v25
  s_waitcnt vmcnt(0)
L_p1_h:
  s_barrier
L_b4:
  s_cmp_ge_u32 s3, 8
  s_cbranch_scc1 L_g0_5
  buffer_store_dwordx4 v[72:75], v42, s[32:35], 0 offen sc1
  buffer_store_dwordx4 v[72:75], v30, s[32:35], 0 offen sc1
  buffer_store_dwordx4 v[76:79], v43, s[32:35], 0 offen sc1
  buffer_store_dwordx4 v[76:79], v31, s[32:35], 0 offen sc1
L_g0_5:
  v_and_b32 v12, 15, v68
  v_lshrrev_b32 v13, 4, v68
  v_mov_b32 v20, 0xffff80
  v_mov_b32 v21, 0xffff80
  v_mov_b32 v22, 0xffff80
  v_mov_b32 v23, 0xffff80
  v_lshl_add_u32 v17, v68, 4, s52
  ds_write_b128 v17, v[20:23] offset:6144
  ds_write_b128 v17, v[20:23] offset:6528
  v_bfe_u32 v16, v68, 2, 1
  v_bfe_u32 v14, v68, 3, 1
  v_lshl_add_u32 v16, v13, 1, v16
  v_lshl_add_u32 v16, v16, 7, s52
  v_lshl_add_u32 v16, v14, 10, v16
  v_and_b32 v18, 1, v13
  v_lshl_add_u32 v17, v18, 1, v14
  v_lshl_add_u32 v16, v17, 5, v16
  v_and_b32 v17, 3, v68
  v_lshl_add_u32 v32, v17, 3, v16
  v_xor_b32 v33, 32, v32
  v_xor_b32 v34, 64, v32
  v_xor_b32 v35, 96, v32
  v_and_b32 v16, 7, v68
  v_lshlrev_b32 v18, 2, v18
  v_xor_b32 v17, v18, v16
  v_lshlrev_b32 v36, 4, v17
  v_xor_b32 v37, 32, v36
  s_mov_b32 s56, 0x01010101
  v_mul_lo_u32 v40, v12, s56
  v_not_b32 v40, v40
  s_mov_b32 s60, 0x40404041
  s_mov_b32 s61, 0x40004000
  s_mov_b32 s7, 0xffff80
  s_movk_i32 s56, 144
  v_lshl_add_u32 v17, v13, 3, s52
  v_mad_u32_u24 v66, v12, s56, v17
  v_cmp_gt_u32 vcc, 14, v12
  v_mov_b32 v17, 2147483648
  v_lshrrev_b32 v18, 3, v68
  v_cndmask_b32 v66, v17, v66, vcc
  v_lshl_add_u32 v17, v16, 4, s52
  v_mad_u32_u24 v67, v18, s56, v17
  v_lshl_add_u32 v17, v13, 4, s52
  v_mad_u32_u24 v64, v14, s56, v17
  v_lshl_add_u32 v65, v12, 6, s52
  v_mov_b32 v63, 1.0
  ds_write_b128 v67, v[44:47]
  ds_write_b128 v67, v[48:51] offset:1152
  v_lshrrev_b32 v16, 3, v68
  v_lshl_add_u32 v16, v16, 2, s52
  ds_write_b32 v16, v26 offset:2304
  ds_write_b32 v16, v27 offset:2336
  v_and_b32 v17, 15, v68
  v_lshl_add_u32 v17, v17, 2, s52
  ds_read_b64 v[44:45], v66 offset:0
  ds_read_b64 v[46:47], v66 offset:32
  ds_read_b64 v[48:49], v66 offset:64
  ds_read_b64 v[50:51], v66 offset:96
  ds_read_b32 v41, v17 offset:2304
  s_waitcnt lgkmcnt(0)
  v_lshlrev_b32 v0, 16, v44
  v_and_b32 v1, 0xffff0000, v44
  v_lshlrev_b32 v2, 16, v45
  v_and_b32 v3, 0xffff0000, v45
  v_lshlrev_b32 v4, 16, v46
  v_and_b32 v5, 0xffff0000, v46
  v_lshlrev_b32 v6, 16, v47
  v_and_b32 v7, 0xffff0000, v47
  v_lshlrev_b32 v8, 16, v48
  v_and_b32 v9, 0xffff0000, v48
  v_lshlrev_b32 v10, 16, v49
  v_and_b32 v11, 0xffff0000, v49
  v_lshlrev_b32 v12, 16, v50
  v_and_b32 v13, 0xffff0000, v50
  v_lshlrev_b32 v14, 16, v51
  v_and_b32 v15, 0xffff0000, v51
  v_add_f32 v24, v0, v2
  v_add_f32 v25, v1, v3
  v_mul_f32 v48, v0, v0
  v_mul_f32 v49, v1, v1
  v_fmac_f32 v48, v2, v2
  v_fmac_f32 v49, v3, v3
  v_add_f32 v24, v24, v4
  v_fmac_f32 v48, v4, v4
  v_add_f32 v25, v25, v5
  v_fmac_f32 v49, v5, v5
  v_add_f32 v24, v24, v6
  v_fmac_f32 v48, v6, v6
  v_add_f32 v25, v25, v7
  v_fmac_f32 v49, v7, v7
  v_add_f32 v24, v24, v8
  v_fmac_f32 v48, v8, v8
  v_add_f32 v25, v25, v9
  v_fmac_f32 v49, v9, v9
  v_add_f32 v24, v24, v10
  v_fmac_f32 v48, v10, v10
  v_add_f32 v25, v25, v11
  v_fmac_f32 v49, v11, v11
  v_add_f32 v24, v24, v12
  v_fmac_f32 v48, v12, v12
  v_add_f32 v25, v25, v13
  v_fmac_f32 v49, v13, v13
  v_add_f32 v24, v24, v14
  v_fmac_f32 v48, v14, v14
  v_add_f32 v25, v25, v15
  v_fmac_f32 v49, v15, v15
  v_add_f32 v24, v24, v25
  v_add_f32 v48, v48, v49
  v_mul_f32 v49, v63, v63
  s_nop 0
  v_permlane16_swap_b32 v24, v48
  v_add_f32 v24, v24, v48
  v_mov_b32 v48, v24
  v_mov_b32 v50, 0x3727c5ac
  s_nop 0
  v_permlane32_swap_b32 v24, v48
  v_add_f32 v24, v24, v48
  v_mul_f32 v24, 0x3c800000, v24
  v_mov_b32 v48, v24
  s_lshl_b32 s56, s53, 3
  v_add_u32 v51, s56, v65
  v_permlane16_swap_b32 v24, v48
  v_fma_f32 v48, -v24, v24, v48
  v_max_f32 v48, 0, v48
  v_fmac_f32 v50, v49, v48
  v_rsq_f32 v49, v50
  v_mul_f32 v27, v24, v63
  v_mul_f32 v26, v50, v49
  v_mul_f32 v48, v49, v63
  v_mul_f32 v49, v49, v27
  ds_write_b64 v51, v[26:27] offset:7936
  v_fma_f32 v0, v48, v0, -v49
  v_fma_f32 v1, v48, v1, -v49
  v_fma_f32 v2, v48, v2, -v49
  v_fma_f32 v3, v48, v3, -v49
  v_cvt_pk_bf16_f32 v16, v0, v1
  v_cvt_pk_bf16_f32 v17, v2, v3
  ds_write_b64 v66, v[16:17] offset:4096
  v_fma_f32 v4, v48, v4, -v49
  v_fma_f32 v5, v48, v5, -v49
  v_fma_f32 v6, v48, v6, -v49
  v_fma_f32 v7, v48, v7, -v49
  v_cvt_pk_bf16_f32 v18, v4, v5
  v_cvt_pk_bf16_f32 v19, v6, v7
  ds_write_b64 v66, v[18:19] offset:4128
  v_fma_f32 v8, v48, v8, -v49
  v_fma_f32 v9, v48, v9, -v49
  v_fma_f32 v10, v48, v10, -v49
  v_fma_f32 v11, v48, v11, -v49
  v_cvt_pk_bf16_f32 v20, v8, v9
  v_cvt_pk_bf16_f32 v21, v10, v11
  ds_write_b64 v66, v[20:21] offset:4160
  v_fma_f32 v12, v48, v12, -v49
  v_fma_f32 v13, v48, v13, -v49
  v_fma_f32 v14, v48, v14, -v49
  v_fma_f32 v15, v48, v15, -v49
  v_cvt_pk_bf16_f32 v22, v12, v13
  v_cvt_pk_bf16_f32 v23, v14, v15
  ds_write_b64 v66, v[22:23] offset:4192
  s_lshl_b32 s11, 0x01010101, s53
L_b5:
  s_lshl_b32 s75, s89, 2
  s_add_u32 s75, s75, 4194304
  v_lshrrev_b32 v121, 2, v62
  v_lshlrev_b32 v122, 10, v121
  s_barrier
  buffer_load_dword v120, v122, s[36:39], s75 offen sc1
  s_mov_b32 s63, 1
  v_mul_u32_u24 v121, 12544, v121
  v_and_b32 v122, 3, v62
  v_mov_b32 v22, 2147483648
  v_mov_b32 v23, 5242880
  v_mov_b32 v24, 7904
  v_mov_b32 v21, 1
  v_mul_f32 v63, 0.5, v41
  v_mul_f32 v41, v63, v41
  v_and_b32 v70, 63, v68
  v_lshlrev_b32 v70, 7, v70
  v_mov_b32 v71, 0
  v_mov_b32 v96, 0x10000000
  v_mov_b32 v97, 0x10000000
  v_mov_b32 v98, 0x10000000
  v_mov_b32 v99, 0x10000000
  v_mov_b32 v100, 0x10000000
  v_mov_b32 v101, 0x10000000
  v_mov_b32 v102, 0x10000000
  v_mov_b32 v103, 0x10000000
  s_waitcnt vmcnt(0)
  v_and_b32 v123, 0xffff, v120
  v_lshrrev_b32 v120, 16, v120
  v_lshl_add_u32 v121, v123, 2, v121
  v_lshl_add_u32 v123, v122, 4, v121
  buffer_load_dwordx4 v[80:83], v123, s[36:39], 0 offen sc1
  v_sub_u32 v16, v120, v122
  v_cmp_lt_i32 vcc, 16, v16
  v_lshl_add_u32 v123, v122, 2, v121
  v_mad_i32_i24 v17, v122, -3, v120
  v_cndmask_b32 v123, v22, v123, vcc
  buffer_load_dword v87, v123, s[36:39], 0 offen offset:64 sc1
  v_cmp_lt_i32 vcc, 20, v17
  v_mad_u32_u24 v123, v122, 12, v121
  v_sub_u32 v18, v17, v122
  s_or_b32 s74, vcc_lo, vcc_hi
  s_cbranch_scc0 L_p2r
  v_cndmask_b32 v123, v22, v123, vcc
  buffer_load_dwordx3 v[84:86], v123, s[36:39], 0 offen offset:80 sc1
  v_cmp_lt_i32 vcc, 32, v120
  s_cbranch_vccz L_p2r
  ds_write_b32 v24, v21
L_p2r:
  s_mov_b32 s59, 159744
  s_mov_b64 exec, 1
  ds_add_rtn_u32 v25, v24, v21 offset:8
  s_mov_b64 exec, -1
  s_lshr_b32 s57, s2, 2
  s_lshl_b32 s57, s57, 7
  s_add_u32 s57, s57, 32768
  s_add_u32 s58, s57, 8192
  s_waitcnt lgkmcnt(0)
  v_readfirstlane_b32 s56, v25
  s_nop 0
  s_cmp_lg_u32 s56, 15
  s_cbranch_scc1 L_p2a
  s_atomic_add s63, s[92:93], s57
  s_atomic_add s63, s[92:93], s58
L_p2a:
  s_waitcnt vmcnt(0)
  v_lshrrev_b32 v19, 24, v80
  v_lshl_add_u32 v88, v19, 2, s59
  v_lshrrev_b32 v19, 24, v81
  v_lshl_add_u32 v89, v19, 2, s59
  v_lshrrev_b32 v19, 24, v82
  v_lshl_add_u32 v90, v19, 2, s59
  v_lshrrev_b32 v19, 24, v83
  v_lshl_add_u32 v91, v19, 2, s59
  v_lshrrev_b32 v19, 24, v87
  v_lshl_add_u32 v95, v19, 2, s59
  v_cmpx_lt_i32 vcc, 0, v18
  ds_add_rtn_u32 v96, v88, v21
  v_cmpx_lt_i32 vcc, 1, v18
  ds_add_rtn_u32 v97, v89, v21
  v_cmpx_lt_i32 vcc, 2, v18
  ds_add_rtn_u32 v98, v90, v21
  v_cmpx_lt_i32 vcc, 3, v18
  ds_add_rtn_u32 v99, v91, v21
  s_mov_b64 exec, -1
  v_cmpx_lt_i32 vcc, 16, v16
  ds_add_rtn_u32 v103, v95, v21
  s_mov_b64 exec, -1
  s_cmp_eq_u32 s74, 0
  s_cbranch_scc1 L_p2s
  v_lshrrev_b32 v19, 24, v84
  v_lshl_add_u32 v92, v19, 2, s59
  v_lshrrev_b32 v19, 24, v85
  v_lshl_add_u32 v93, v19, 2, s59
  v_lshrrev_b32 v19, 24, v86
  v_lshl_add_u32 v94, v19, 2, s59
  v_cmpx_lt_i32 vcc, 20, v17
  ds_add_rtn_u32 v100, v92, v21
  v_cmpx_lt_i32 vcc, 21, v17
  ds_add_rtn_u32 v101, v93, v21
  v_cmpx_lt_i32 vcc, 22, v17
  ds_add_rtn_u32 v102, v94, v21
  s_mov_b64 exec, -1
L_p2s:
  buffer_load_dwordx2 v[124:125], v23, s[36:39], s77 offen sc1
  s_cmp_lt_u32 s3, 8
  s_cbranch_scc1 L_g0_6
  buffer_store_dwordx4 v[72:75], v42, s[32:35], 0 offen sc1
  buffer_store_dwordx4 v[72:75], v30, s[32:35], 0 offen sc1
  buffer_store_dwordx4 v[76:79], v43, s[32:35], 0 offen sc1
  buffer_store_dwordx4 v[76:79], v31, s[32:35], 0 offen sc1
L_g0_6:
  v_mov_b32 v20, v24
  s_mov_b32 s64, 0x11111111
  s_mov_b32 s65, 0x11111111
  s_mov_b32 s78, 0x33333333
  s_mov_b32 s79, 0x33333333
  v_lshrrev_b32 v25, 2, v68
  v_mul_u32_u24 v24, 2240, v25
  s_mov_b32 s59, 5275648
  s_waitcnt lgkmcnt(0)
  s_barrier
  s_cmp_lg_u32 s3, 15
  s_cbranch_scc1 L_p2q
  buffer_load_dword v127, v70, s[36:39], s59 offen sc1
L_p2q:
  ds_read_b32 v20, v20
  v_lshlrev_b32 v61, 4, v68
  v_add_u32 v61, 159744, v61
  ds_read_b128 v[52:55], v61
  s_waitcnt lgkmcnt(0)
  v_add_u32 v58, v52, v53
  v_add_u32 v59, v58, v54
  v_add_u32 v56, v59, v55
  s_nop 1
  v_mov_b32_dpp v57, v56 quad_perm:[0,0,1,2] row_mask:0xf bank_mask:0xf
  v_cndmask_b32 v57, v57, 0, s[64:65]
  v_add_u32 v60, v56, v57
  s_nop 1
  v_mov_b32_dpp v57, v60 quad_perm:[0,0,0,1] row_mask:0xf bank_mask:0xf
  v_cndmask_b32 v57, v57, 0, s[78:79]
  v_add_u32 v60, v60, v57
  v_sub_u32 v56, v60, v56
  v_add_u32 v56, v24, v56
  v_add_u32 v57, v56, v52
  v_add_u32 v58, v56, v58
  v_add_u32 v59, v56, v59
  ds_write_b128 v61, v[56:59] offset:1024
  ds_read_b32 v104, v88 offset:1024
  ds_read_b32 v105, v89 offset:1024
  ds_read_b32 v106, v90 offset:1024
  ds_read_b32 v107, v91 offset:1024
  ds_read_b32 v111, v95 offset:1024
  s_lshl_b32 s56, s3, 2
  s_add_u32 s56, s56, 3
  v_readlane_b32 s48, v60, s56
  s_sub_u32 s56, s56, 2
  v_readlane_b32 s5, v58, s56
  v_cmp_lt_u32 vcc, 352, v60
  v_readfirstlane_b32 s54, v20
  s_add_u32 s48, s48, 15
  s_lshr_b32 s48, s48, 4
  s_lshr_b32 s56, s52, 2
  s_sub_u32 s5, s5, s56
  s_lshr_b32 s5, s5, 4
  s_mul_i32 s56, s48, 26
  s_add_u32 s56, s56, 32
  s_lshr_b32 s56, s56, 6
  s_min_u32 s5, s5, s56
  s_lshl_b32 s6, s48, 20
  s_or_b32 s56, vcc_lo, vcc_hi
  s_or_b32 s54, s54, s56
  s_cbranch_scc1 L_p2d
  s_waitcnt lgkmcnt(4)
  v_add_lshl_u32 v104, v104, v96, 2
  ds_write_b32 v104, v80 offset:6144
  s_waitcnt lgkmcnt(4)
  v_add_lshl_u32 v105, v105, v97, 2
  ds_write_b32 v105, v81 offset:6144
  s_waitcnt lgkmcnt(4)
  v_add_lshl_u32 v106, v106, v98, 2
  ds_write_b32 v106, v82 offset:6144
  s_waitcnt lgkmcnt(4)
  v_add_lshl_u32 v107, v107, v99, 2
  ds_write_b32 v107, v83 offset:6144
  s_waitcnt lgkmcnt(4)
  v_add_lshl_u32 v111, v111, v103, 2
  ds_write_b32 v111, v87 offset:6144
  s_cmp_eq_u32 s74, 0
  s_cbranch_scc1 L_p2d
  ds_read_b32 v108, v92 offset:1024
  ds_read_b32 v109, v93 offset:1024
  ds_read_b32 v110, v94 offset:1024
  s_waitcnt lgkmcnt(2)
  v_add_lshl_u32 v108, v108, v100, 2
  ds_write_b32 v108, v84 offset:6144
  s_waitcnt lgkmcnt(2)
  v_add_lshl_u32 v109, v109, v101, 2
  ds_write_b32 v109, v85 offset:6144
  s_waitcnt lgkmcnt(2)
  v_add_lshl_u32 v110, v110, v102, 2
  ds_write_b32 v110, v86 offset:6144
L_p2d:
  s_cmp_lt_u32 s3, 8
  s_cselect_b32 s56, 15, 15
  s_mul_i32 s56, s48, s56
  s_add_u32 s56, s56, 32
  s_lshr_b32 s56, s56, 6
  s_min_u32 s56, s56, s5
  s_lshl_b32 s56, s56, 0
  s_or_b32 s6, s6, s56
  s_lshl_b32 s56, s5, 5
  s_or_b32 s6, s6, s56
  s_cmp_lt_u32 s3, 8
  s_cselect_b32 s56, 38, 38
  s_mul_i32 s56, s48, s56
  s_add_u32 s56, s56, 32
  s_lshr_b32 s56, s56, 6
  s_max_u32 s56, s56, s5
  s_lshl_b32 s56, s56, 10
  s_or_b32 s6, s6, s56
  s_cmp_lt_u32 s3, 8
  s_cselect_b32 s56, 51, 51
  s_mul_i32 s56, s48, s56
  s_add_u32 s56, s56, 32
  s_lshr_b32 s56, s56, 6
  s_max_u32 s56, s56, s5
  s_lshl_b32 s56, s56, 15
  s_or_b32 s6, s6, s56
  s_sub_u32 s5, s5, 2
  s_cmp_eq_u32 s3, 2
  s_cselect_b32 s5, s5, -1
  s_cselect_b32 s67, 3, -1
  s_cmp_eq_u32 s54, 0
  s_cselect_b32 s55, 4, 0
  s_cselect_b32 s48, s48, 4
  s_cselect_b32 s6, s6, 0
  s_add_u32 s53, s53, 1
  s_add_u32 s32, s32, 16777216
  s_addc_u32 s33, s33, 0
  s_mov_b32 s50, s6
  s_and_b32 s9, s50, 31
  s_mov_b32 s71, 0
  s_mov_b32 s72, 0
  s_mov_b32 s73, 0
  s_waitcnt vmcnt(0)
  v_cmp_gt_u32 s[64:65], v124, v125
  v_mov_b32 v19, 0x2000
  s_nop 0
  v_cndmask_b32 v19, 0, v19, s[64:65]
  v_or_b32 v36, v36, v19
  v_or_b32 v37, v37, v19
  v_readfirstlane_b32 s10, v19
  v_xor_b32 v42, v42, v19
  v_xor_b32 v43, v43, v19
  s_add_u32 s10, s10, 5275648
  s_cmp_lg_u32 s3, 15
  s_cbranch_scc1 L_p2e
  v_cmp_gt_u32 vcc, 4, v127
  s_cbranch_vccz L_p2e
  s_mov_b32 s4, s59
  s_mov_b32 s69, 4
L_pl_7:
  buffer_load_dword v18, v70, s[36:39], s4 offen sc1
  s_waitcnt vmcnt(0)
  v_cmp_gt_u32 vcc, s69, v18
  s_cbranch_vccz L_pd_8
  s_sleep 8
  s_add_u32 s62, s62, 1
  s_cmp_lt_u32 s62, 16777216
  s_cbranch_scc1 L_pl_7
  s_endpgm
L_pd_8:
L_p2e:
  v_and_b32 v70, 63, v68
  v_lshlrev_b32 v70, 7, v70
  s_add_u32 s4, s10, 16384
  s_mov_b32 s69, 4
  s_mov_b32 s68, 1
  s_waitcnt lgkmcnt(0)
  s_barrier
  v_lshrrev_b32 v38, 3, v68
  v_lshl_add_u32 v38, v38, 3, s52
  v_lshrrev_b32 v39, 4, v68
  v_lshl_add_u32 v39, v39, 2, s52
  ds_read_b64 v[44:45], v38 offset:6144
  ds_read_b64 v[46:47], v38 offset:6208
  ds_read_b64 v[28:29], v38 offset:6272
  s_mov_b32 s51, s55
  s_mov_b32 s8, 0
  s_waitcnt lgkmcnt(0)
  v_bitop3_b32 v44, v44, s7, v36 bitop3:0x6a
  v_bitop3_b32 v45, v45, s7, v37 bitop3:0x6a
  v_bitop3_b32 v46, v46, s7, v36 bitop3:0x6a
  v_bitop3_b32 v47, v47, s7, v37 bitop3:0x6a
  s_cmp_lg_u32 s3, 14
  s_cbranch_scc1 L_p2f
  s_lshr_b32 s57, s2, 2
  s_lshl_b32 s57, s57, 7
  s_add_u32 s57, s57, 49152
  s_add_u32 s58, s57, 8192
  s_atomic_add s68, s[92:93], s57
  s_atomic_add s68, s[92:93], s58
L_p2f:
  s_setprio 3
  s_mov_b32 m0, s52
  s_cmp_ge_u32 s9, 2
  s_cbranch_scc1 L_fast
L_hop:
  s_cmp_eq_u32 s54, 0
  s_cbranch_scc1 L_gather
  s_cmp_lg_u32 s3, 15
  s_cbranch_scc1 L_slow0
L_pl_9:
  buffer_load_dword v17, v70, s[36:39], s4 offen sc1
  s_waitcnt vmcnt(0)
  v_cmp_gt_u32 vcc, s69, v17
  s_cbranch_vccz L_pd_10
  s_sleep 8
  s_add_u32 s62, s62, 1
  s_cmp_lt_u32 s62, 16777216
  s_cbranch_scc1 L_pl_9
  s_endpgm
L_pd_10:
L_slow0:
  s_mov_b32 s9, 4
  s_barrier
  s_cmp_eq_u32 s11, 0
  s_cbranch_scc1 L_sc_11
  s_mov_b32 exec_lo, s11
  s_mov_b32 exec_hi, s11
  ds_read_b128 v[72:75], v64 offset:4096
  ds_read_b128 v[76:79], v64 offset:4160
  ds_read_b128 v[80:83], v64 offset:4384
  ds_read_b128 v[84:87], v64 offset:4448
  ds_read_b128 v[88:91], v64 offset:4672
  ds_read_b128 v[92:95], v64 offset:4736
  ds_read_b128 v[96:99], v64 offset:4960
  ds_read_b128 v[100:103], v64 offset:5024
  ds_read_b128 v[104:107], v64 offset:5248
  ds_read_b128 v[108:111], v64 offset:5312
  ds_read_b128 v[112:115], v64 offset:5536
  ds_read_b128 v[116:119], v64 offset:5600
  s_cmp_eq_u32 s88, 32
  s_cbranch_scc1 L_sc_11b
  ds_read_b128 v[120:123], v64 offset:5824
  ds_read_b128 v[124:127], v64 offset:5888
L_sc_11b:
  s_mov_b64 exec, -1
  s_mov_b32 s11, 0
  v_mov_b32 v0, 0
  v_mov_b32 v1, 0
  v_mov_b32 v2, 0
  v_mov_b32 v3, 0
  v_mov_b32 v4, 0
  v_mov_b32 v5, 0
  v_mov_b32 v6, 0
  v_mov_b32 v7, 0
  v_mov_b32 v8, 0
  v_mov_b32 v9, 0
  v_mov_b32 v10, 0
  v_mov_b32 v11, 0
  v_mov_b32 v12, 0
  v_mov_b32 v13, 0
  v_mov_b32 v14, 0
  v_mov_b32 v15, 0
L_sc_11:
L_slow:
  s_cmp_lt_u32 s72, s73
  s_cbranch_scc1 L_slow2
  s_cmp_ge_u32 s71, 256
  s_cbranch_scc1 L_gdone
  s_lshl_b32 s56, s71, 10
  v_mov_b32 v16, s56
  buffer_load_dword v17, v16, s[36:39], s75 offen sc1
  s_mul_i32 s74, s71, 12544
  s_add_u32 s71, s71, 1
  s_mov_b32 s72, 0
  s_waitcnt vmcnt(0)
  v_readfirstlane_b32 s56, v17
  s_nop 0
  s_lshr_b32 s73, s56, 16
  s_and_b32 s56, s56, 0xffff
  s_lshl_b32 s56, s56, 2
  s_add_u32 s74, s74, s56
  s_branch L_slow
L_slow2:
  v_add_u32 v16, s72, v68
  v_lshl_add_u32 v17, v16, 2, s74
  buffer_load_dword v18, v17, s[36:39], 0 offen sc1
  s_add_u32 s72, s72, 64
  v_cmp_gt_u32 s[64:65], s73, v16
  s_waitcnt vmcnt(0)
  v_lshrrev_b32 v19, 28, v18
  v_cmp_eq_u32 vcc, s3, v19
  s_nop 0
  s_and_b64 s[64:65], s[64:65], vcc
  v_mov_b32 v20, v18
  v_and_b32 v21, 15, v18
  v_mov_b32 v22, 0xffff80
  v_cndmask_b32 v20, v22, v20, s[64:65]
  v_lshl_add_u32 v22, v68, 2, s52
  v_add_u32 v23, s52, v68
  ds_write_b32 v22, v20 offset:6144
  ds_write_b8 v23, v21 offset:7552
  v_lshrrev_b32 v38, 3, v68
  v_lshl_add_u32 v38, v38, 3, s52
  v_lshrrev_b32 v39, 4, v68
  v_lshl_add_u32 v39, v39, 2, s52
  ds_read_b64 v[44:45], v38 offset:6144
  ds_read_b64 v[46:47], v38 offset:6208
  ds_read_b64 v[28:29], v38 offset:6272
  s_mov_b32 s51, s55
  s_mov_b32 s8, 0
  s_waitcnt lgkmcnt(0)
  v_bitop3_b32 v44, v44, s7, v36 bitop3:0x6a
  v_bitop3_b32 v45, v45, s7, v37 bitop3:0x6a
  v_bitop3_b32 v46, v46, s7, v36 bitop3:0x6a
  v_bitop3_b32 v47, v47, s7, v37 bitop3:0x6a
L_gather:
L_pap0:
  s_cmp_lt_u32 s8, s9
  s_cbranch_scc1 L_pbp0
  s_cmp_eq_u32 s51, 0
  s_cbranch_scc1 L_pbp0
  s_sub_u32 s51, s51, 1
  s_lshr_b32 s50, s50, 5
  s_and_b32 s9, s50, 31
  s_cmp_lg_u32 s51, 2
  s_cbranch_scc1 L_pzp0
  s_cmp_lg_u32 s3, 2
  s_cbranch_scc1 L_pzp0
  s_waitcnt vmcnt(4)
  v_cmp_gt_u32 vcc, s69, v71
  s_cbranch_vccz L_pzp0
L_pl_12:
  buffer_load_dword v71, v70, s[36:39], s4 offen sc1
  s_waitcnt vmcnt(0)
  v_cmp_gt_u32 vcc, s69, v71
  s_cbranch_vccz L_pd_13
  s_sleep 8
  s_add_u32 s62, s62, 1
  s_cmp_lt_u32 s62, 16777216
  s_cbranch_scc1 L_pl_12
  s_endpgm
L_pd_13:
L_pzp0:
  s_barrier
  s_branch L_pap0
L_pbp0:
  s_cmp_le_u32 s48, 0
  s_cbranch_scc1 L_gl0
  s_add_u32 m0, s52, 0
  s_add_u32 s8, s8, 1
  buffer_load_dwordx4 v44, s[28:31], 0 offen sc1 lds
  s_add_u32 m0, s52, 1024
  s_nop 0
  buffer_load_dwordx4 v45, s[28:31], 0 offen sc1 lds
L_pap1:
  s_cmp_lt_u32 s8, s9
  s_cbranch_scc1 L_pbp1
  s_cmp_eq_u32 s51, 0
  s_cbranch_scc1 L_pbp1
  s_sub_u32 s51, s51, 1
  s_lshr_b32 s50, s50, 5
  s_and_b32 s9, s50, 31
  s_cmp_lg_u32 s51, 2
  s_cbranch_scc1 L_pzp1
  s_cmp_lg_u32 s3, 2
  s_cbranch_scc1 L_pzp1
  s_waitcnt vmcnt(4)
  v_cmp_gt_u32 vcc, s69, v71
  s_cbranch_vccz L_pzp1
L_pl_14:
  buffer_load_dword v71, v70, s[36:39], s4 offen sc1
  s_waitcnt vmcnt(0)
  v_cmp_gt_u32 vcc, s69, v71
  s_cbranch_vccz L_pd_15
  s_sleep 8
  s_add_u32 s62, s62, 1
  s_cmp_lt_u32 s62, 16777216
  s_cbranch_scc1 L_pl_14
  s_endpgm
L_pd_15:
L_pzp1:
  s_barrier
  s_branch L_pap1
L_pbp1:
  s_cmp_le_u32 s48, 1
  s_cbranch_scc1 L_gl0
  s_add_u32 m0, s52, 2048
  s_add_u32 s8, s8, 1
  buffer_load_dwordx4 v46, s[28:31], 0 offen sc1 lds
  s_add_u32 m0, s52, 3072
  s_nop 0
  buffer_load_dwordx4 v47, s[28:31], 0 offen sc1 lds
L_gl0:
  s_cmp_lg_u32 s11, 0x01010101
  s_cbranch_scc1 L_gl1
  v_lshl_add_u32 v27, v68, 4, s52
  ds_read_b128 v[16:19], v27 offset:6144
  ds_read_b128 v[20:23], v27 offset:6528
  v_lshl_add_u32 v27, v68, 2, s52
  s_mov_b32 s56, 0x0c0c0400
  s_mov_b32 s57, 0x0f0f0f0f
  s_waitcnt lgkmcnt(0)
  v_perm_b32 v16, v17, v16, s56
  v_perm_b32 v18, v19, v18, s56
  v_lshl_or_b32 v16, v18, 16, v16
  v_and_b32 v16, s57, v16
  ds_write_b32 v27, v16 offset:7552
  v_perm_b32 v20, v21, v20, s56
  v_perm_b32 v22, v23, v22, s56
  v_lshl_or_b32 v20, v22, 16, v20
  v_and_b32 v20, s57, v20
  ds_write_b32 v27, v20 offset:7648
L_gl1:
  ds_read_b32 v16, v39 offset:7552
  s_cmp_eq_u32 s11, 0
  s_cbranch_scc1 L_sc_16
  s_mov_b32 exec_lo, s11
  s_mov_b32 exec_hi, s11
  ds_read_b128 v[72:75], v64 offset:4096
  ds_read_b128 v[76:79], v64 offset:4160
  ds_read_b128 v[80:83], v64 offset:4384
  ds_read_b128 v[84:87], v64 offset:4448
  ds_read_b128 v[88:91], v64 offset:4672
  ds_read_b128 v[92:95], v64 offset:4736
  ds_read_b128 v[96:99], v64 offset:4960
  ds_read_b128 v[100:103], v64 offset:5024
  ds_read_b128 v[104:107], v64 offset:5248
  ds_read_b128 v[108:111], v64 offset:5312
  ds_read_b128 v[112:115], v64 offset:5536
  ds_read_b128 v[116:119], v64 offset:5600
  s_cmp_eq_u32 s88, 32
  s_cbranch_scc1 L_sc_16b
  ds_read_b128 v[120:123], v64 offset:5824
  ds_read_b128 v[124:127], v64 offset:5888
L_sc_16b:
  s_mov_b64 exec, -1
  s_mov_b32 s11, 0
  v_mov_b32 v0, 0
  v_mov_b32 v1, 0
  v_mov_b32 v2, 0
  v_mov_b32 v3, 0
  v_mov_b32 v4, 0
  v_mov_b32 v5, 0
  v_mov_b32 v6, 0
  v_mov_b32 v7, 0
  v_mov_b32 v8, 0
  v_mov_b32 v9, 0
  v_mov_b32 v10, 0
  v_mov_b32 v11, 0
  v_mov_b32 v12, 0
  v_mov_b32 v13, 0
  v_mov_b32 v14, 0
  v_mov_b32 v15, 0
L_sc_16:
  s_waitcnt lgkmcnt(0)
  v_xad_u32 v17, v16, v40, s60
  v_bitop3_b32 v30, v28, s7, v36 bitop3:0x6a
  v_bitop3_b32 v31, v29, s7, v37 bitop3:0x6a
  v_and_b32 v25, s61, v17
  v_lshlrev_b32 v17, 8, v17
  v_and_b32 v24, s61, v17
  s_sub_i32 s56, s9, s8
  s_cmp_gt_i32 s56, 3
  s_branch L_ec1
L_m0:
  s_waitcnt vmcnt(2)
  ds_read_b64_tr_b16 v[44:45], v32 offset:0
  ds_read_b64_tr_b16 v[48:49], v33 offset:0
  ds_read_b64_tr_b16 v[52:53], v34 offset:0
  ds_read_b64_tr_b16 v[56:57], v35 offset:0
  ds_read_b64 v[28:29], v38 offset:6336
  ds_read_b32 v16, v39 offset:7568
  s_add_u32 m0, s52, 0
  s_cmp_eq_u32 s8, s5
  s_cbranch_scc1 L_pp0
L_pq0:
  s_add_u32 s8, s8, 1
  s_sub_i32 s56, s9, s8
  s_waitcnt lgkmcnt(2)
  buffer_load_dwordx4 v30, s[28:31], 0 offen sc1 lds
  s_add_u32 m0, s52, 1024
  s_nop 0
  buffer_load_dwordx4 v31, s[28:31], 0 offen sc1 lds
  s_cmp_gt_i32 s56, 3
  s_cbranch_scc1 L_pc0_
  s_cmp_gt_i32 s56, 2
  s_setprio 2
  s_cbranch_scc1 L_pc0_
  s_cmp_gt_i32 s56, 1
  s_setprio 1
  s_cbranch_scc1 L_pc0_
  s_cmp_le_i32 s56, 0
  s_setprio 3
  s_cbranch_scc1 L_pc0_
  s_setprio 0
L_pc0_:
  s_waitcnt lgkmcnt(0)
  v_xad_u32 v17, v16, v40, s60
  v_bitop3_b32 v30, v28, s7, v36 bitop3:0x6a
  v_bitop3_b32 v31, v29, s7, v37 bitop3:0x6a
  v_and_b32 v27, s61, v17
  v_lshlrev_b32 v17, 8, v17
  v_and_b32 v26, s61, v17
  s_cmp_le_i32 s56, 0
  s_cbranch_scc1 L_ev0
L_m1:
  s_waitcnt vmcnt(2)
  ds_read_b64_tr_b16 v[46:47], v32 offset:2048
  ds_read_b64_tr_b16 v[50:51], v33 offset:2048
  ds_read_b64_tr_b16 v[54:55], v34 offset:2048
  ds_read_b64_tr_b16 v[58:59], v35 offset:2048
  ds_read_b64 v[28:29], v38 offset:6400
  ds_read_b32 v16, v39 offset:7584
  s_add_u32 m0, s52, 2048
  s_cmp_eq_u32 s8, s5
  s_cbranch_scc1 L_pp1
L_pq1:
  s_add_u32 s8, s8, 1
  s_sub_i32 s56, s9, s8
  s_waitcnt lgkmcnt(2)
  buffer_load_dwordx4 v30, s[28:31], 0 offen sc1 lds
  s_add_u32 m0, s52, 3072
  v_mfma_f32_16x16x32_bf16 v[0:3], v[44:47], v[24:27], v[0:3]
  buffer_load_dwordx4 v31, s[28:31], 0 offen sc1 lds
  v_mfma_f32_16x16x32_bf16 v[4:7], v[48:51], v[24:27], v[4:7]
  v_add_u32 v38, 128, v38
  v_mfma_f32_16x16x32_bf16 v[8:11], v[52:55], v[24:27], v[8:11]
  v_add_u32 v39, 32, v39
  v_mfma_f32_16x16x32_bf16 v[12:15], v[56:59], v[24:27], v[12:15]
  s_cmp_gt_i32 s56, 3
  s_cbranch_scc1 L_pc1_
  s_cmp_gt_i32 s56, 2
  s_setprio 2
  s_cbranch_scc1 L_pc1_
  s_cmp_gt_i32 s56, 1
  s_setprio 1
  s_cbranch_scc1 L_pc1_
  s_cmp_le_i32 s56, 0
  s_setprio 3
  s_cbranch_scc1 L_pc1_
  s_setprio 0
L_pc1_:
  s_waitcnt lgkmcnt(0)
  v_xad_u32 v17, v16, v40, s60
  v_bitop3_b32 v30, v28, s7, v36 bitop3:0x6a
  v_bitop3_b32 v31, v29, s7, v37 bitop3:0x6a
  v_and_b32 v25, s61, v17
  v_lshlrev_b32 v17, 8, v17
  v_and_b32 v24, s61, v17
  s_cmp_gt_i32 s56, 0
  s_cbranch_scc1 L_m0
L_ev1:
  s_cmp_eq_u32 s51, s67
  s_cbranch_scc1 L_eg1
  s_sub_u32 s51, s51, 1
  s_cbranch_scc1 L_ee1
L_eb1:
  s_lshr_b32 s50, s50, 5
  s_setprio 3
  s_and_b32 s9, s50, 31
  s_sub_i32 s56, s9, s8
  s_cmp_gt_i32 s56, 3
  s_barrier
L_ec1:
  s_setprio 3
  s_cbranch_scc1 L_m0
  s_cmp_gt_i32 s56, 2
  s_setprio 2
  s_cbranch_scc1 L_m0
  s_cmp_gt_i32 s56, 1
  s_setprio 1
  s_cbranch_scc1 L_m0
  s_cmp_gt_i32 s56, 0
  s_setprio 0
  s_cbranch_scc1 L_m0
  s_branch L_ev1
L_eg1:
  s_sub_u32 s51, s51, 1
  s_waitcnt vmcnt(4)
  v_cmp_gt_u32 vcc, s69, v71
  s_cbranch_vccz L_eb1
L_pl_17:
  buffer_load_dword v71, v70, s[36:39], s4 offen sc1
  s_waitcnt vmcnt(0)
  v_cmp_gt_u32 vcc, s69, v71
  s_cbranch_vccz L_pd_18
  s_sleep 8
  s_add_u32 s62, s62, 1
  s_cmp_lt_u32 s62, 16777216
  s_cbranch_scc1 L_pl_17
  s_endpgm
L_pd_18:
  s_branch L_eb1
L_pp1:
  buffer_load_dword v71, v70, s[36:39], s4 offen sc1
  s_branch L_pq1
L_ee1:
  s_setprio 3
L_t0:
  s_cmp_eq_u32 s48, 0
  s_cbranch_scc1 L_gend
  s_cmp_eq_u32 s48, 1
  s_cbranch_scc1 L_u0
  s_waitcnt vmcnt(2)
  ds_read_b64_tr_b16 v[44:45], v32 offset:0
  ds_read_b64_tr_b16 v[48:49], v33 offset:0
  ds_read_b64_tr_b16 v[52:53], v34 offset:0
  ds_read_b64_tr_b16 v[56:57], v35 offset:0
  ds_read_b32 v16, v39 offset:7568
  s_waitcnt lgkmcnt(1)
  s_waitcnt lgkmcnt(0)
  v_xad_u32 v17, v16, v40, s60
  v_and_b32 v27, s61, v17
  v_lshlrev_b32 v17, 8, v17
  v_and_b32 v26, s61, v17
L_u1:
  s_waitcnt vmcnt(0)
  ds_read_b64_tr_b16 v[46:47], v32 offset:2048
  ds_read_b64_tr_b16 v[50:51], v33 offset:2048
  ds_read_b64_tr_b16 v[54:55], v34 offset:2048
  ds_read_b64_tr_b16 v[58:59], v35 offset:2048
  s_waitcnt lgkmcnt(3)
  v_mfma_f32_16x16x32_bf16 v[0:3], v[44:47], v[24:27], v[0:3]
  s_waitcnt lgkmcnt(2)
  v_mfma_f32_16x16x32_bf16 v[4:7], v[48:51], v[24:27], v[4:7]
  s_waitcnt lgkmcnt(1)
  v_mfma_f32_16x16x32_bf16 v[8:11], v[52:55], v[24:27], v[8:11]
  s_waitcnt lgkmcnt(0)
  v_mfma_f32_16x16x32_bf16 v[12:15], v[56:59], v[24:27], v[12:15]
  s_branch L_gend
L_ev0:
  s_cmp_eq_u32 s51, s67
  s_cbranch_scc1 L_eg0
  s_sub_u32 s51, s51, 1
  s_cbranch_scc1 L_ee0
L_eb0:
  s_lshr_b32 s50, s50, 5
  s_setprio 3
  s_and_b32 s9, s50, 31
  s_sub_i32 s56, s9, s8
  s_cmp_gt_i32 s56, 3
  s_barrier
L_ec0:
  s_setprio 3
  s_cbranch_scc1 L_m1
  s_cmp_gt_i32 s56, 2
  s_setprio 2
  s_cbranch_scc1 L_m1
  s_cmp_gt_i32 s56, 1
  s_setprio 1
  s_cbranch_scc1 L_m1
  s_cmp_gt_i32 s56, 0
  s_setprio 0
  s_cbranch_scc1 L_m1
  s_branch L_ev0
L_eg0:
  s_sub_u32 s51, s51, 1
  s_waitcnt vmcnt(4)
  v_cmp_gt_u32 vcc, s69, v71
  s_cbranch_vccz L_eb0
L_pl_19:
  buffer_load_dword v71, v70, s[36:39], s4 offen sc1
  s_waitcnt vmcnt(0)
  v_cmp_gt_u32 vcc, s69, v71
  s_cbranch_vccz L_pd_20
  s_sleep 8
  s_add_u32 s62, s62, 1
  s_cmp_lt_u32 s62, 16777216
  s_cbranch_scc1 L_pl_19
  s_endpgm
L_pd_20:
  s_branch L_eb0
L_pp0:
  buffer_load_dword v71, v70, s[36:39], s4 offen sc1
  s_branch L_pq0
L_ee0:
  s_setprio 3
L_t1:
  s_waitcnt vmcnt(2)
  ds_read_b64_tr_b16 v[46:47], v32 offset:2048
  ds_read_b64_tr_b16 v[50:51], v33 offset:2048
  ds_read_b64_tr_b16 v[54:55], v34 offset:2048
  ds_read_b64_tr_b16 v[58:59], v35 offset:2048
  ds_read_b32 v16, v39 offset:7584
  s_waitcnt lgkmcnt(1)
  v_mfma_f32_16x16x32_bf16 v[0:3], v[44:47], v[24:27], v[0:3]
  v_mfma_f32_16x16x32_bf16 v[4:7], v[48:51], v[24:27], v[4:7]
  v_mfma_f32_16x16x32_bf16 v[8:11], v[52:55], v[24:27], v[8:11]
  v_mfma_f32_16x16x32_bf16 v[12:15], v[56:59], v[24:27], v[12:15]
  s_waitcnt lgkmcnt(0)
  v_xad_u32 v17, v16, v40, s60
  v_and_b32 v25, s61, v17
  v_lshlrev_b32 v17, 8, v17
  v_and_b32 v24, s61, v17
L_u0:
  s_waitcnt vmcnt(0)
  ds_read_b64_tr_b16 v[44:45], v32 offset:0
  ds_read_b64_tr_b16 v[48:49], v33 offset:0
  ds_read_b64_tr_b16 v[52:53], v34 offset:0
  ds_read_b64_tr_b16 v[56:57], v35 offset:0
  s_waitcnt lgkmcnt(3)
  v_mfma_f32_16x16x16_bf16 v[0:3], v[44:45], v[24:25], v[0:3]
  s_waitcnt lgkmcnt(2)
  v_mfma_f32_16x16x16_bf16 v[4:7], v[48:49], v[24:25], v[4:7]
  s_waitcnt lgkmcnt(1)
  v_mfma_f32_16x16x16_bf16 v[8:11], v[52:53], v[24:25], v[8:11]
  s_waitcnt lgkmcnt(0)
  v_mfma_f32_16x16x16_bf16 v[12:15], v[56:57], v[24:25], v[12:15]
L_gend:
  s_cmp_lg_u32 s54, 0
  s_cbranch_scc1 L_slow
L_gdone:
  v_xor_b32 v30, 0x2000, v42
  v_xor_b32 v31, 0x2000, v43
  s_cmp_eq_u32 s53, 7
  s_cbranch_scc1 L_final
  v_mul_f32 v44, v41, v0
  v_mul_f32 v45, v41, v1
  v_mul_f32 v46, v41, v2
  v_mul_f32 v47, v41, v3
  v_cvt_pk_bf16_f32 v16, v44, v45
  v_cvt_pk_bf16_f32 v17, v46, v47
  ds_write_b64 v66, v[16:17] offset:0
  v_mul_f32 v48, v41, v4
  v_mul_f32 v49, v41, v5
  v_mul_f32 v50, v41, v6
  v_mul_f32 v51, v41, v7
  v_cvt_pk_bf16_f32 v18, v48, v49
  v_cvt_pk_bf16_f32 v19, v50, v51
  ds_write_b64 v66, v[18:19] offset:32
  v_mul_f32 v44, v41, v8
  v_mul_f32 v45, v41, v9
  v_mul_f32 v46, v41, v10
  v_mul_f32 v47, v41, v11
  v_cvt_pk_bf16_f32 v20, v44, v45
  v_cvt_pk_bf16_f32 v21, v46, v47
  ds_write_b64 v66, v[20:21] offset:64
  v_mul_f32 v48, v41, v12
  v_mul_f32 v49, v41, v13
  v_mul_f32 v50, v41, v14
  v_mul_f32 v51, v41, v15
  v_cvt_pk_bf16_f32 v22, v48, v49
  v_cvt_pk_bf16_f32 v23, v50, v51
  ds_write_b64 v66, v[22:23] offset:96
  ds_read_b128 v[52:55], v67
  ds_read_b128 v[56:59], v67 offset:1152
  s_cmp_ge_u32 s3, 8
  s_cbranch_scc1 L_gs1
  s_waitcnt lgkmcnt(1)
  buffer_store_dwordx4 v[52:55], v30, s[32:35], 0 offen sc1
  buffer_store_dwordx4 v[52:55], v42, s[32:35], 0 offen sc1
  s_waitcnt lgkmcnt(0)
  buffer_store_dwordx4 v[56:59], v31, s[32:35], 0 offen sc1
  buffer_store_dwordx4 v[56:59], v43, s[32:35], 0 offen sc1
L_gs1:
  s_setprio 0
  v_lshrrev_b32 v38, 3, v68
  v_lshl_add_u32 v38, v38, 3, s52
  v_lshrrev_b32 v39, 4, v68
  v_lshl_add_u32 v39, v39, 2, s52
  ds_read_b64 v[44:45], v38 offset:6144
  ds_read_b64 v[46:47], v38 offset:6208
  ds_read_b64 v[28:29], v38 offset:6272
  s_mov_b32 s51, s55
  s_mov_b32 s8, 0
  s_waitcnt lgkmcnt(0)
  v_bitop3_b32 v44, v44, s7, v36 bitop3:0x6a
  v_bitop3_b32 v45, v45, s7, v37 bitop3:0x6a
  v_bitop3_b32 v46, v46, s7, v36 bitop3:0x6a
  v_bitop3_b32 v47, v47, s7, v37 bitop3:0x6a
  s_add_u32 s63, s63, 1
  s_add_u32 s28, s28, 16777216
  s_addc_u32 s29, s29, 0
  s_cmp_ge_u32 s3, 8
  s_cbranch_scc1 L_hL
  s_waitcnt vmcnt(0)
  s_lshr_b32 s57, s2, 2
  s_lshl_b32 s57, s57, 7
  s_add_u32 s57, s57, 32768
  s_add_u32 s58, s57, 8192
  s_cmp_lg_u32 s3, 0
  s_barrier
  s_cbranch_scc1 L_hs
  s_atomic_add s68, s[92:93], s57
  s_atomic_add s68, s[92:93], s58
L_hs:
  v_add_f32 v24, v0, v2
  v_add_f32 v25, v1, v3
  v_mul_f32 v48, v0, v0
  v_mul_f32 v49, v1, v1
  v_fmac_f32 v48, v2, v2
  v_fmac_f32 v49, v3, v3
  v_add_f32 v24, v24, v4
  v_fmac_f32 v48, v4, v4
  v_add_f32 v25, v25, v5
  v_fmac_f32 v49, v5, v5
  v_add_f32 v24, v24, v6
  v_fmac_f32 v48, v6, v6
  v_add_f32 v25, v25, v7
  v_fmac_f32 v49, v7, v7
  v_add_f32 v24, v24, v8
  v_fmac_f32 v48, v8, v8
  v_add_f32 v25, v25, v9
  v_fmac_f32 v49, v9, v9
  v_add_f32 v24, v24, v10
  v_fmac_f32 v48, v10, v10
  v_add_f32 v25, v25, v11
  v_fmac_f32 v49, v11, v11
  v_add_f32 v24, v24, v12
  v_fmac_f32 v48, v12, v12
  v_add_f32 v25, v25, v13
  v_fmac_f32 v49, v13, v13
  v_add_f32 v24, v24, v14
  v_fmac_f32 v48, v14, v14
  v_add_f32 v25, v25, v15
  v_fmac_f32 v49, v15, v15
  v_add_f32 v24, v24, v25
  v_add_f32 v48, v48, v49
  v_mul_f32 v49, v63, v63
  s_nop 0
  v_permlane16_swap_b32 v24, v48
  v_add_f32 v24, v24, v48
  v_mov_b32 v48, v24
  v_mov_b32 v50, 0x3727c5ac
  s_nop 0
  v_permlane32_swap_b32 v24, v48
  v_add_f32 v24, v24, v48
  v_mul_f32 v24, 0x3c800000, v24
  v_mov_b32 v48, v24
  s_lshl_b32 s56, s53, 3
  v_add_u32 v51, s56, v65
  v_permlane16_swap_b32 v24, v48
  v_fma_f32 v48, -v24, v24, v48
  v_max_f32 v48, 0, v48
  v_fmac_f32 v50, v49, v48
  v_rsq_f32 v49, v50
  v_mul_f32 v27, v24, v63
  v_mul_f32 v26, v50, v49
  v_mul_f32 v48, v49, v63
  v_mul_f32 v49, v49, v27
  ds_write_b64 v51, v[26:27] offset:7936
  v_fma_f32 v0, v48, v0, -v49
  v_fma_f32 v1, v48, v1, -v49
  v_fma_f32 v2, v48, v2, -v49
  v_fma_f32 v3, v48, v3, -v49
  v_cvt_pk_bf16_f32 v16, v0, v1
  v_cvt_pk_bf16_f32 v17, v2, v3
  ds_write_b64 v66, v[16:17] offset:4096
  v_fma_f32 v4, v48, v4, -v49
  v_fma_f32 v5, v48, v5, -v49
  v_fma_f32 v6, v48, v6, -v49
  v_fma_f32 v7, v48, v7, -v49
  v_cvt_pk_bf16_f32 v18, v4, v5
  v_cvt_pk_bf16_f32 v19, v6, v7
  ds_write_b64 v66, v[18:19] offset:4128
  v_fma_f32 v8, v48, v8, -v49
  v_fma_f32 v9, v48, v9, -v49
  v_fma_f32 v10, v48, v10, -v49
  v_fma_f32 v11, v48, v11, -v49
  v_cvt_pk_bf16_f32 v20, v8, v9
  v_cvt_pk_bf16_f32 v21, v10, v11
  ds_write_b64 v66, v[20:21] offset:4160
  v_fma_f32 v12, v48, v12, -v49
  v_fma_f32 v13, v48, v13, -v49
  v_fma_f32 v14, v48, v14, -v49
  v_fma_f32 v15, v48, v15, -v49
  v_cvt_pk_bf16_f32 v22, v12, v13
  v_cvt_pk_bf16_f32 v23, v14, v15
  ds_write_b64 v66, v[22:23] offset:4192
  s_lshl_b32 s11, 0x01010101, s53
  s_branch L_hM
L_hL:
  v_add_f32 v24, v0, v2
  v_add_f32 v25, v1, v3
  v_mul_f32 v48, v0, v0
  v_mul_f32 v49, v1, v1
  v_fmac_f32 v48, v2, v2
  v_fmac_f32 v49, v3, v3
  v_add_f32 v24, v24, v4
  v_fmac_f32 v48, v4, v4
  v_add_f32 v25, v25, v5
  v_fmac_f32 v49, v5, v5
  v_add_f32 v24, v24, v6
  v_fmac_f32 v48, v6, v6
  v_add_f32 v25, v25, v7
  v_fmac_f32 v49, v7, v7
  v_add_f32 v24, v24, v8
  v_fmac_f32 v48, v8, v8
  v_add_f32 v25, v25, v9
  v_fmac_f32 v49, v9, v9
  v_add_f32 v24, v24, v10
  v_fmac_f32 v48, v10, v10
  v_add_f32 v25, v25, v11
  v_fmac_f32 v49, v11, v11
  v_add_f32 v24, v24, v12
  v_fmac_f32 v48, v12, v12
  v_add_f32 v25, v25, v13
  v_fmac_f32 v49, v13, v13
  v_add_f32 v24, v24, v14
  v_fmac_f32 v48, v14, v14
  v_add_f32 v25, v25, v15
  v_fmac_f32 v49, v15, v15
  v_add_f32 v24, v24, v25
  v_add_f32 v48, v48, v49
  s_barrier
  buffer_store_dwordx4 v[52:55], v30, s[32:35], 0 offen sc1
  buffer_store_dwordx4 v[52:55], v42, s[32:35], 0 offen sc1
  buffer_store_dwordx4 v[56:59], v31, s[32:35], 0 offen sc1
  buffer_store_dwordx4 v[56:59], v43, s[32:35], 0 offen sc1
  v_mul_f32 v49, v63, v63
  v_permlane16_swap_b32 v24, v48
  v_add_f32 v24, v24, v48
  v_mov_b32 v48, v24
  v_mov_b32 v50, 0x3727c5ac
  s_nop 0
  v_permlane32_swap_b32 v24, v48
  v_add_f32 v24, v24, v48
  v_mul_f32 v24, 0x3c800000, v24
  v_mov_b32 v48, v24
  s_lshl_b32 s56, s53, 3
  v_add_u32 v51, s56, v65
  v_permlane16_swap_b32 v24, v48
  v_fma_f32 v48, -v24, v24, v48
  v_max_f32 v48, 0, v48
  v_fmac_f32 v50, v49, v48
  v_rsq_f32 v49, v50
  v_mul_f32 v27, v24, v63
  v_mul_f32 v26, v50, v49
  v_mul_f32 v48, v49, v63
  v_mul_f32 v49, v49, v27
  ds_write_b64 v51, v[26:27] offset:7936
  v_fma_f32 v0, v48, v0, -v49
  v_fma_f32 v1, v48, v1, -v49
  v_fma_f32 v2, v48, v2, -v49
  v_fma_f32 v3, v48, v3, -v49
  v_cvt_pk_bf16_f32 v16, v0, v1
  v_cvt_pk_bf16_f32 v17, v2, v3
  ds_write_b64 v66, v[16:17] offset:4096
  v_fma_f32 v4, v48, v4, -v49
  v_fma_f32 v5, v48, v5, -v49
  v_fma_f32 v6, v48, v6, -v49
  v_fma_f32 v7, v48, v7, -v49
  v_cvt_pk_bf16_f32 v18, v4, v5
  v_cvt_pk_bf16_f32 v19, v6, v7
  ds_write_b64 v66, v[18:19] offset:4128
  v_fma_f32 v8, v48, v8, -v49
  v_fma_f32 v9, v48, v9, -v49
  v_fma_f32 v10, v48, v10, -v49
  v_fma_f32 v11, v48, v11, -v49
  v_cvt_pk_bf16_f32 v20, v8, v9
  v_cvt_pk_bf16_f32 v21, v10, v11
  ds_write_b64 v66, v[20:21] offset:4160
  v_fma_f32 v12, v48, v12, -v49
  v_fma_f32 v13, v48, v13, -v49
  v_fma_f32 v14, v48, v14, -v49
  v_fma_f32 v15, v48, v15, -v49
  v_cvt_pk_bf16_f32 v22, v12, v13
  v_cvt_pk_bf16_f32 v23, v14, v15
  ds_write_b64 v66, v[22:23] offset:4192
  s_lshl_b32 s11, 0x01010101, s53
  s_waitcnt vmcnt(0)
  s_and_b32 s59, s3, 8
  v_mov_b32 v60, s59
  v_mov_b32 v61, 1
  s_mov_b64 exec, 1
  ds_add_rtn_u32 v60, v60, v61 offset:7908
  s_mov_b64 exec, -1
  s_lshl_b32 s59, s59, 11
  s_lshr_b32 s57, s2, 2
  s_lshl_b32 s57, s57, 7
  s_add_u32 s57, s57, s59
  s_add_u32 s57, s57, 32768
  s_add_u32 s58, s57, 8192
  s_waitcnt lgkmcnt(0)
  v_readfirstlane_b32 s59, v60
  s_nop 0
  s_and_b32 s59, s59, 7
  s_cmp_lg_u32 s59, 7
  s_cbranch_scc1 L_cb_21
  s_atomic_add s68, s[92:93], s57
  s_atomic_add s68, s[92:93], s58
L_cb_21:
L_hM:
L_hB:
  s_add_u32 s53, s53, 1
  s_add_u32 s32, s32, 16777216
  s_addc_u32 s33, s33, 0
  s_mov_b32 s50, s6
  s_and_b32 s9, s50, 31
  s_mov_b32 s71, 0
  s_mov_b32 s72, 0
  s_mov_b32 s73, 0
  s_min_i32 s5, s5, 3
  v_mov_b32 v71, 0
  s_mul_i32 s69, s63, 4
L_jch:
  s_cmp_lt_u32 s89, 254
  s_cbranch_scc1 L_jend
  s_cmp_lg_u32 s53, 2
  s_cbranch_scc1 L_jend
  v_lshrrev_b32 v1, 4, v68
  v_lshlrev_b32 v5, 4, v68
  s_lshl_b32 s59, s3, 10
  s_add_u32 s59, s59, 5767168
  s_cmp_eq_u32 s89, 254
  s_cbranch_scc1 L_jr
  v_bfe_u32 v0, v68, 2, 2
  v_and_b32 v2, 3, v68
  v_lshl_add_u32 v0, v0, 3, v2
  s_and_b32 s56, s3, 1
  s_lshl_b32 s56, s56, 12
  s_and_b32 s57, s3, 4
  s_lshl_b32 s57, s57, 3
  s_and_b32 s58, s3, 2
  s_lshl_b32 s58, s58, 1
  s_add_u32 s57, s57, s58
  v_lshlrev_b32 v2, 7, v0
  v_lshl_add_u32 v2, v1, 4, v2
  s_cmp_ge_u32 s3, 8
  s_cbranch_scc1 L_jw
  s_mov_b32 s40, s12
  s_mov_b32 s41, s13
  s_mov_b32 s42, 8192
  s_mov_b32 s43, 0x20000
  s_mov_b32 s44, s14
  s_mov_b32 s45, s15
  s_mov_b32 s46, 8192
  s_mov_b32 s47, 0x20000
  buffer_load_dwordx4 v[8:11], v2, s[40:43], s56 offen
  buffer_load_dwordx4 v[12:15], v2, s[40:43], s56 offen offset:64
  buffer_load_dwordx4 v[16:19], v2, s[40:43], s56 offen offset:512
  buffer_load_dwordx4 v[20:23], v2, s[40:43], s56 offen offset:576
  s_lshl_b32 s57, s57, 7
  buffer_load_dwordx4 v[24:27], v2, s[44:47], s57 offen
  buffer_load_dwordx4 v[28:31], v2, s[44:47], s57 offen offset:64
  s_mov_b32 s58, 0x3e38aa3b
  s_waitcnt vmcnt(0)
  s_branch L_jm
L_jw:
  s_mov_b32 s40, s16
  s_mov_b32 s41, s17
  s_mov_b32 s42, 8192
  s_mov_b32 s43, 0x20000
  s_mov_b32 s44, s18
  s_mov_b32 s45, s19
  s_mov_b32 s46, 8192
  s_mov_b32 s47, 0x20000
  buffer_load_dwordx4 v[8:11], v2, s[40:43], s56 offen
  buffer_load_dwordx4 v[12:15], v2, s[40:43], s56 offen offset:64
  buffer_load_dwordx4 v[16:19], v2, s[40:43], s56 offen offset:512
  buffer_load_dwordx4 v[20:23], v2, s[40:43], s56 offen offset:576
  s_lshl_b32 s57, s57, 1
  v_lshlrev_b32 v3, 1, v0
  v_lshl_add_u32 v3, v1, 10, v3
  v_add_u32 v4, 4096, v3
  buffer_load_ushort v44, v3, s[44:47], s57 offen offset:0
  buffer_load_ushort v45, v3, s[44:47], s57 offen offset:128
  buffer_load_ushort v46, v3, s[44:47], s57 offen offset:256
  buffer_load_ushort v47, v3, s[44:47], s57 offen offset:384
  buffer_load_ushort v48, v3, s[44:47], s57 offen offset:512
  buffer_load_ushort v49, v3, s[44:47], s57 offen offset:640
  buffer_load_ushort v50, v3, s[44:47], s57 offen offset:768
  buffer_load_ushort v51, v3, s[44:47], s57 offen offset:896
  buffer_load_ushort v52, v4, s[44:47], s57 offen offset:0
  buffer_load_ushort v53, v4, s[44:47], s57 offen offset:128
  buffer_load_ushort v54, v4, s[44:47], s57 offen offset:256
  buffer_load_ushort v55, v4, s[44:47], s57 offen offset:384
  buffer_load_ushort v56, v4, s[44:47], s57 offen offset:512
  buffer_load_ushort v57, v4, s[44:47], s57 offen offset:640
  buffer_load_ushort v58, v4, s[44:47], s57 offen offset:768
  buffer_load_ushort v59, v4, s[44:47], s57 offen offset:896
  s_waitcnt vmcnt(0)
  v_lshl_or_b32 v24, v45, 16, v44
  v_lshl_or_b32 v25, v47, 16, v46
  v_lshl_or_b32 v26, v49, 16, v48
  v_lshl_or_b32 v27, v51, 16, v50
  v_lshl_or_b32 v28, v53, 16, v52
  v_lshl_or_b32 v29, v55, 16, v54
  v_lshl_or_b32 v30, v57, 16, v56
  v_lshl_or_b32 v31, v59, 16, v58
  s_mov_b32 s58, 1.0
L_jm:
  v_mfma_f32_16x16x32_bf16 v[44:47], v[8:11], v[24:27], 0
  v_mfma_f32_16x16x32_bf16 v[48:51], v[16:19], v[24:27], 0
  v_mfma_f32_16x16x32_bf16 v[44:47], v[12:15], v[28:31], v[44:47]
  v_mfma_f32_16x16x32_bf16 v[48:51], v[20:23], v[28:31], v[48:51]
  s_nop 6
  v_mul_f32 v44, s58, v44
  v_mul_f32 v45, s58, v45
  v_mul_f32 v46, s58, v46
  v_mul_f32 v47, s58, v47
  v_mul_f32 v48, s58, v48
  v_mul_f32 v49, s58, v49
  v_mul_f32 v50, s58, v50
  v_mul_f32 v51, s58, v51
  v_cvt_pk_bf16_f32 v52, v44, v45
  v_cvt_pk_bf16_f32 v53, v46, v47
  v_cvt_pk_bf16_f32 v54, v48, v49
  v_cvt_pk_bf16_f32 v55, v50, v51
  buffer_store_dwordx4 v[52:55], v5, s[36:39], s59 offen sc1
  s_branch L_jp
L_jr:
  s_cmp_ge_u32 s3, 2
  s_cbranch_scc1 L_jend
  s_mov_b32 s40, s20
  s_mov_b32 s41, s21
  s_mov_b32 s42, 128
  s_mov_b32 s43, 0x20000
  v_lshlrev_b32 v2, 4, v1
  s_lshl_b32 s56, s3, 6
  buffer_load_dwordx4 v[8:11], v2, s[40:43], s56 offen
  v_lshlrev_b32 v3, 1, v68
  buffer_load_ushort v4, v3, s[40:43], 0 offen
  s_mov_b32 s64, 0x11111111
  s_mov_b32 s65, 0x11111111
  s_mov_b32 s78, 0x22222222
  s_mov_b32 s79, 0x22222222
  v_mov_b32 v6, 0x3c803c80
  v_cndmask_b32 v6, 0, v6, s[64:65]
  s_add_u32 s59, s59, 16384
  s_waitcnt vmcnt(0)
  v_cndmask_b32 v52, v6, v8, s[78:79]
  v_cndmask_b32 v53, v6, v9, s[78:79]
  v_cndmask_b32 v54, v6, v10, s[78:79]
  v_cndmask_b32 v55, v6, v11, s[78:79]
  buffer_store_dwordx4 v[52:55], v5, s[36:39], s59 offen sc1
  v_lshlrev_b32 v4, 16, v4
  s_nop 1
  v_add_f32_dpp v4, v4, v4 quad_perm:[1,0,3,2] row_mask:0xf bank_mask:0xf
  s_nop 1
  v_add_f32_dpp v4, v4, v4 quad_perm:[2,3,0,1] row_mask:0xf bank_mask:0xf
  s_nop 1
  v_add_f32_dpp v4, v4, v4 row_half_mirror row_mask:0xf bank_mask:0xf
  s_nop 1
  v_add_f32_dpp v4, v4, v4 row_mirror row_mask:0xf bank_mask:0xf
  v_mov_b32 v6, v4
  s_nop 1
  v_permlane16_swap_b32 v6, v4
  v_add_f32 v4, v4, v6
  v_mov_b32 v6, v4
  s_nop 1
  v_permlane32_swap_b32 v6, v4
  v_add_f32 v4, v4, v6
  s_mov_b32 s56, 5785600
  v_lshlrev_b32 v3, 2, v68
  v_mov_b32 v56, v4
  buffer_store_dword v56, v3, s[36:39], s56 offen sc1
L_jp:
  v_lshrrev_b32 v38, 3, v68
  v_lshl_add_u32 v38, v38, 3, s52
  v_lshrrev_b32 v39, 4, v68
  v_lshl_add_u32 v39, v39, 2, s52
  ds_read_b64 v[44:45], v38 offset:6144
  ds_read_b64 v[46:47], v38 offset:6208
  ds_read_b64 v[28:29], v38 offset:6272
  s_mov_b32 s51, s55
  s_mov_b32 s8, 0
  s_waitcnt lgkmcnt(0)
  v_bitop3_b32 v44, v44, s7, v36 bitop3:0x6a
  v_bitop3_b32 v45, v45, s7, v37 bitop3:0x6a
  v_bitop3_b32 v46, v46, s7, v36 bitop3:0x6a
  v_bitop3_b32 v47, v47, s7, v37 bitop3:0x6a
L_jend:
  s_cmp_lg_u32 s11, 0x8080808
  s_cbranch_scc1 L_hD
  s_lshl_b32 s56, s3, 10
  s_add_u32 m0, s56, 143360
  s_add_u32 s56, s56, 5767168
  v_lshlrev_b32 v18, 4, v68
  buffer_load_dwordx4 v18, s[36:39], s56 offen sc1 lds
  v_mov_b32 v19, 5785600
  buffer_load_dword v62, v19, s[36:39], 0 offen sc1
  s_cmp_ge_u32 s3, 4
  s_cbranch_scc1 L_hD
  s_add_u32 m0, m0, 16384
  s_cmp_ge_u32 s3, 2
  s_cbranch_scc1 L_hE
  s_add_u32 s56, s56, 16384
  buffer_load_dwordx4 v18, s[36:39], s56 offen sc1 lds
  s_branch L_hD
L_hE:
  s_getpc_b64 s[94:95]
L_pc2:
  s_lshl_b32 s56, s3, 10
  s_add_u32 s56, s56, lane_table-L_pc2-2048
  v_add_u32 v18, s56, v18
  global_load_lds_dwordx4 v18, s[94:95]
L_hD:
  s_setprio 3
  s_mov_b32 m0, s52
  s_cmp_lg_u32 s3, 15
  s_cbranch_scc1 L_jbh
L_jah:
  v_lshlrev_b32 v19, 7, v68
  s_mov_b32 exec_lo, 0xffffffff
  s_mov_b32 exec_hi, 0xffffffff
L_pl_22_0:
  buffer_load_dword v18, v19, s[36:39], s10 offen sc1
  s_waitcnt vmcnt(0)
  v_cmpx_gt_u32 vcc, s69, v18
  s_cbranch_execz L_pd_23_0
  s_bcnt1_i32_b64 s56, exec
  s_cmp_le_u32 s56, 16
  s_cbranch_scc1 L_pl_22_n
  s_mov_b64 s[64:65], exec
  s_ff1_i32_b64 s56, exec
  s_lshl_b64 exec, 1, s56
L_pl_22_o:
  buffer_load_dword v18, v19, s[36:39], s10 offen sc1
  s_waitcnt vmcnt(0)
  v_cmp_gt_u32 vcc, s69, v18
  s_cbranch_vccz L_pl_22_q
  s_add_u32 s62, s62, 1
  s_cmp_lt_u32 s62, 16777216
  s_cbranch_scc1 L_pl_22_o
  s_endpgm
L_pl_22_q:
  s_mov_b64 exec, s[64:65]
L_pl_22_n:
  s_add_u32 s62, s62, 1
  s_cmp_lt_u32 s62, 16777216
  s_cbranch_scc1 L_pl_22_0
  s_endpgm
L_pd_23_0:
L_pd_23:
  s_mov_b64 exec, -1
L_jbh:
  s_cmp_lt_u32 s9, 2
  s_barrier
  s_cbranch_scc1 L_hop
L_fast:
  buffer_load_dwordx4 v44, s[28:31], 0 offen sc1 lds
  s_add_u32 m0, s52, 1024
  s_mov_b32 s8, 2
  buffer_load_dwordx4 v45, s[28:31], 0 offen sc1 lds
  s_add_u32 m0, s52, 2048
  s_nop 0
  buffer_load_dwordx4 v46, s[28:31], 0 offen sc1 lds
  s_add_u32 m0, s52, 3072
  s_nop 0
  buffer_load_dwordx4 v47, s[28:31], 0 offen sc1 lds
  s_branch L_gl0
L_final:
  s_setprio 0
  s_mov_b32 s40, s22
  s_mov_b32 s41, s23
  s_mov_b32 s42, 6400000
  s_mov_b32 s43, 0x20000
  v_readfirstlane_b32 s12, v62
  s_mov_b32 s78, 0x80808080
  s_mov_b32 s79, 0x80808080
  s_mov_b32 vcc_lo, 0x00ff00ff
  s_mov_b32 vcc_hi, 0xff00ff00
  s_mov_b32 s64, 0x33333333
  s_mov_b32 s65, 0x33333333
  s_mov_b32 s4, 0x55555555
  s_mov_b32 s5, 0x55555555
  s_mov_b32 s13, 0x3727c5ac
  s_lshl_b32 s59, s49, 7
  s_add_u32 s58, s59, 8192
  s_sub_u32 s56, s52, 71680
  s_mov_b32 s14, 0xf000f
  s_mov_b32 s15, 0xf000f
  s_mov_b32 s16, 0xf000f0
  s_mov_b32 s17, 0xf000f0
  s_mov_b32 s18, 0xf000f00
  s_mov_b32 s19, 0xf000f00
  s_mov_b32 s20, 0xf000f000
  s_mov_b32 s21, 0xf000f000
  s_cmp_eq_u32 s88, 32
  s_cbranch_scc1 L_fin6
  v_mul_f32 v48, v0, v0
  v_mul_f32 v49, v1, v1
  v_add_f32 v44, v0, v2
  v_add_f32 v45, v1, v3
  v_fmac_f32 v48, v2, v2
  v_fmac_f32 v49, v3, v3
  v_add_f32 v44, v44, v4
  v_fmac_f32 v48, v4, v4
  v_add_f32 v45, v45, v5
  v_fmac_f32 v49, v5, v5
  v_add_f32 v44, v44, v6
  v_fmac_f32 v48, v6, v6
  v_add_f32 v45, v45, v7
  v_fmac_f32 v49, v7, v7
  v_add_f32 v44, v44, v8
  v_fmac_f32 v48, v8, v8
  v_add_f32 v45, v45, v9
  v_fmac_f32 v49, v9, v9
  v_add_f32 v44, v44, v10
  v_fmac_f32 v48, v10, v10
  v_add_f32 v45, v45, v11
  v_fmac_f32 v49, v11, v11
  v_add_f32 v44, v44, v12
  v_fmac_f32 v48, v12, v12
  v_add_f32 v45, v45, v13
  v_fmac_f32 v49, v13, v13
  v_add_f32 v44, v44, v14
  v_fmac_f32 v48, v14, v14
  v_add_f32 v45, v45, v15
  v_fmac_f32 v49, v15, v15
  v_add_f32 v44, v44, v45
  v_add_f32 v48, v48, v49
  v_mul_f32 v49, v63, v63
  v_mov_b32 v50, 0x3727c5ac
  v_permlane16_swap_b32 v44, v48
  v_add_f32 v44, v44, v48
  v_mov_b32 v48, v44
  v_lshlrev_b32 v69, 4, v68
  v_add_u32 v69, 143360, v69
  v_permlane32_swap_b32 v44, v48
  v_add_f32 v44, v44, v48
  v_mul_f32 v44, 0x3c800000, v44
  v_mov_b32 v48, v44
  ds_read_b32 v70, v69 offset:18432
  ds_read_b128 v[24:27], v69 offset:6144
  v_permlane16_swap_b32 v44, v48
  v_fma_f32 v48, -v44, v44, v48
  v_max_f32 v48, 0, v48
  v_fmac_f32 v50, v49, v48
  v_rsq_f32 v49, v50
  v_mul_f32 v47, v44, v63
  v_mul_f32 v46, v50, v49
  v_mul_f32 v48, v49, v63
  v_mul_f32 v49, v49, v47
  ds_read_b128 v[28:31], v69 offset:7168
  v_fma_f32 v0, v48, v0, -v49
  v_fma_f32 v1, v48, v1, -v49
  v_fma_f32 v2, v48, v2, -v49
  v_fma_f32 v3, v48, v3, -v49
  v_fma_f32 v4, v48, v4, -v49
  v_fma_f32 v5, v48, v5, -v49
  v_fma_f32 v6, v48, v6, -v49
  v_fma_f32 v7, v48, v7, -v49
  ds_write_b64 v65, v[46:47] offset:7992
  v_cvt_pk_bf16_f32 v16, v0, v1
  v_cvt_pk_bf16_f32 v17, v2, v3
  v_cvt_pk_bf16_f32 v18, v4, v5
  v_cvt_pk_bf16_f32 v19, v6, v7
  v_fma_f32 v8, v48, v8, -v49
  v_fma_f32 v9, v48, v9, -v49
  v_fma_f32 v10, v48, v10, -v49
  v_fma_f32 v11, v48, v11, -v49
  v_fma_f32 v12, v48, v12, -v49
  v_fma_f32 v13, v48, v13, -v49
  v_fma_f32 v14, v48, v14, -v49
  v_fma_f32 v15, v48, v15, -v49
  ds_write2_b64 v66, v[16:17], v[18:19] offset0:0 offset1:4
  v_cvt_pk_bf16_f32 v20, v8, v9
  v_cvt_pk_bf16_f32 v21, v10, v11
  v_cvt_pk_bf16_f32 v22, v12, v13
  v_cvt_pk_bf16_f32 v23, v14, v15
  ds_write2_b64 v66, v[20:21], v[22:23] offset0:8 offset1:12
  s_mov_b64 exec, s[78:79]
  ds_read_b128 v[72:75], v64 offset:0
  ds_read_b128 v[76:79], v64 offset:64
  s_mov_b64 exec, -1
  s_mov_b64 exec, s[78:79]
  ds_read_b128 v[80:83], v64 offset:288
  ds_read_b128 v[84:87], v64 offset:352
  s_mov_b64 exec, -1
  s_mov_b64 exec, s[78:79]
  ds_read_b128 v[88:91], v64 offset:576
  ds_read_b128 v[92:95], v64 offset:640
  s_mov_b64 exec, -1
  s_mov_b64 exec, s[78:79]
  ds_read_b128 v[96:99], v64 offset:864
  ds_read_b128 v[100:103], v64 offset:928
  s_mov_b64 exec, -1
  s_mov_b64 exec, s[78:79]
  ds_read_b128 v[104:107], v64 offset:1152
  ds_read_b128 v[108:111], v64 offset:1216
  s_mov_b64 exec, -1
  s_mov_b64 exec, s[78:79]
  ds_read_b128 v[112:115], v64 offset:1440
  ds_read_b128 v[116:119], v64 offset:1504
  s_mov_b64 exec, -1
  s_mov_b64 exec, s[78:79]
  ds_read_b128 v[120:123], v64 offset:1728
  ds_read_b128 v[124:127], v64 offset:1792
  s_mov_b64 exec, -1
  s_waitcnt lgkmcnt(11)
  v_mfma_f32_16x16x32_bf16 v[32:35], v[24:27], v[80:83], 0
  ds_read_b128 v[0:3], v69 offset:0
  ds_read_b128 v[4:7], v69 offset:1024
  s_waitcnt lgkmcnt(12)
  v_mfma_f32_16x16x32_bf16 v[32:35], v[28:31], v[84:87], v[32:35]
  ds_read_b128 v[8:11], v69 offset:2048
  ds_read_b128 v[12:15], v69 offset:3072
  ds_read_b128 v[16:19], v69 offset:4096
  ds_read_b128 v[20:23], v69 offset:5120
  v_mad_u32_u16 v70, v70, 4, s52 op_sel:[0,0,0,0]
  ds_read_b32 v71, v70 offset:7936
  v_lshl_add_u32 v68, v68, 3, s52
  s_nop 0
  v_cvt_pk_bf16_f32 v50, v32, v33
  v_cvt_pk_bf16_f32 v51, v34, v35
  v_mfma_f32_16x16x32_bf16 v[32:35], v[24:27], v[72:75], 0
  v_mfma_f32_16x16x32_bf16 v[32:35], v[28:31], v[76:79], v[32:35]
  s_waitcnt lgkmcnt(6)
  v_mfma_f32_16x16x32_bf16 v[36:39], v[0:3], v[80:83], 0
  s_waitcnt lgkmcnt(4)
  v_mfma_f32_16x16x32_bf16 v[40:43], v[8:11], v[80:83], 0
  v_mfma_f32_16x16x32_bf16 v[36:39], v[4:7], v[84:87], v[36:39]
  s_waitcnt lgkmcnt(3)
  v_mfma_f32_16x16x32_bf16 v[40:43], v[12:15], v[84:87], v[40:43]
  s_waitcnt lgkmcnt(2)
  v_mfma_f32_16x16x32_bf16 v[64:67], v[16:19], v[80:83], 0
  s_waitcnt lgkmcnt(1)
  v_mfma_f32_16x16x32_bf16 v[64:67], v[20:23], v[84:87], v[64:67]
  s_nop 1
  v_cvt_pk_bf16_f32 v44, v36, v37
  v_cvt_pk_bf16_f32 v45, v38, v39
  v_mfma_f32_16x16x32_bf16 v[36:39], v[0:3], v[72:75], 0
  v_cvt_pk_bf16_f32 v46, v40, v41
  v_cvt_pk_bf16_f32 v47, v42, v43
  v_mfma_f32_16x16x32_bf16 v[40:43], v[8:11], v[72:75], 0
  v_cvt_pk_bf16_f32 v48, v64, v65
  v_cvt_pk_bf16_f32 v49, v66, v67
  v_mfma_f32_16x16x32_bf16 v[36:39], v[4:7], v[76:79], v[36:39]
  v_mfma_f32_16x16x32_bf16 v[40:43], v[12:15], v[76:79], v[40:43]
  v_mfma_f32_16x16x32_bf16 v[64:67], v[16:19], v[72:75], 0
  v_mfma_f32_16x16x32_bf16 v[64:67], v[20:23], v[76:79], v[64:67]
  v_mfma_f32_16x16x32_bf16 v[56:59], v[80:83], v[44:47], 0
  v_mfma_f32_16x16x32_bf16 v[56:59], v[84:87], v[48:51], v[56:59]
  v_cvt_pk_bf16_f32 v50, v32, v33
  v_cvt_pk_bf16_f32 v51, v34, v35
  v_mfma_f32_16x16x32_bf16 v[32:35], v[24:27], v[96:99], 0
  v_cvt_pk_bf16_f32 v44, v36, v37
  v_cvt_pk_bf16_f32 v45, v38, v39
  v_mfma_f32_16x16x32_bf16 v[36:39], v[0:3], v[96:99], 0
  v_cvt_pk_bf16_f32 v46, v40, v41
  v_cvt_pk_bf16_f32 v47, v42, v43
  v_mfma_f32_16x16x32_bf16 v[40:43], v[8:11], v[96:99], 0
  v_cvt_pk_bf16_f32 v48, v64, v65
  v_cvt_pk_bf16_f32 v49, v66, v67
  v_mfma_f32_16x16x32_bf16 v[52:55], v[72:75], v[44:47], 0
  s_nop 0
  v_mfma_f32_16x16x32_bf16 v[52:55], v[76:79], v[48:51], v[52:55]
  v_mfma_f32_16x16x32_bf16 v[36:39], v[4:7], v[100:103], v[36:39]
  v_mfma_f32_16x16x32_bf16 v[40:43], v[12:15], v[100:103], v[40:43]
  v_mfma_f32_16x16x32_bf16 v[64:67], v[16:19], v[96:99], 0
  v_mfma_f32_16x16x32_bf16 v[32:35], v[28:31], v[100:103], v[32:35]
  v_mfma_f32_16x16x32_bf16 v[64:67], v[20:23], v[100:103], v[64:67]
  s_nop 2
  v_cndmask_b32_dpp v52, v56, v52, vcc row_ror:8 row_mask:0xf bank_mask:0xf
  v_cvt_pk_bf16_f32 v44, v36, v37
  v_cndmask_b32_dpp v53, v57, v53, vcc row_ror:8 row_mask:0xf bank_mask:0xf
  v_cvt_pk_bf16_f32 v45, v38, v39
  v_mfma_f32_16x16x32_bf16 v[36:39], v[0:3], v[88:91], 0
  v_cndmask_b32_dpp v54, v58, v54, vcc row_ror:8 row_mask:0xf bank_mask:0xf
  v_max3_f32 v60, v52, v53, v54
  v_mfma_f32_16x16x32_bf16 v[36:39], v[4:7], v[92:95], v[36:39]
  v_cndmask_b32_dpp v55, v59, v55, vcc row_ror:8 row_mask:0xf bank_mask:0xf
  v_max_f32 v60, v60, v55
  v_mov_b32 v61, v60
  v_cvt_pk_bf16_f32 v46, v40, v41
  v_cvt_pk_bf16_f32 v47, v42, v43
  v_mfma_f32_16x16x32_bf16 v[40:43], v[8:11], v[88:91], 0
  v_permlane16_swap_b32 v61, v60
  v_mfma_f32_16x16x32_bf16 v[40:43], v[12:15], v[92:95], v[40:43]
  v_max_f32 v60, v60, v61
  v_sub_f32 v52, v52, v60
  v_mfma_f32_16x16x32_bf16 v[56:59], v[96:99], v[44:47], 0
  v_sub_f32 v53, v53, v60
  v_sub_f32 v54, v54, v60
  v_sub_f32 v55, v55, v60
  v_exp_f32 v52, v52
  v_exp_f32 v53, v53
  v_exp_f32 v54, v54
  v_exp_f32 v55, v55
  v_cvt_pk_bf16_f32 v50, v32, v33
  v_cvt_pk_bf16_f32 v51, v34, v35
  v_mfma_f32_16x16x32_bf16 v[32:35], v[24:27], v[88:91], 0
  v_cvt_pk_bf16_f32 v48, v64, v65
  v_cvt_pk_bf16_f32 v49, v66, v67
  v_mfma_f32_16x16x32_bf16 v[64:67], v[16:19], v[88:91], 0
  v_add_f32 v60, v52, v53
  v_add_f32 v61, v54, v55
  v_mfma_f32_16x16x32_bf16 v[32:35], v[28:31], v[92:95], v[32:35]
  v_add_f32 v60, v60, v61
  v_mov_b32 v61, v60
  v_mfma_f32_16x16x32_bf16 v[64:67], v[20:23], v[92:95], v[64:67]
  v_cvt_pk_bf16_f32 v44, v36, v37
  v_permlane16_swap_b32 v61, v60
  v_mfma_f32_16x16x32_bf16 v[56:59], v[100:103], v[48:51], v[56:59]
  v_add_f32 v60, v60, v61
  s_waitcnt lgkmcnt(0)
  v_mul_f32 v60, v60, v71
  v_rcp_f32 v60, v60
  v_cvt_pk_bf16_f32 v45, v38, v39
  v_mfma_f32_16x16x32_bf16 v[36:39], v[0:3], v[112:115], 0
  v_cvt_pk_bf16_f32 v46, v40, v41
  v_cvt_pk_bf16_f32 v47, v42, v43
  v_mfma_f32_16x16x32_bf16 v[40:43], v[8:11], v[112:115], 0
  v_mul_f32 v52, v52, v60
  v_mul_f32 v53, v53, v60
  v_mfma_f32_16x16x32_bf16 v[36:39], v[4:7], v[116:119], v[36:39]
  v_mul_f32 v54, v54, v60
  v_mul_f32 v55, v55, v60
  v_mfma_f32_16x16x32_bf16 v[40:43], v[12:15], v[116:119], v[40:43]
  v_cvt_pk_bf16_f32 v60, v52, v53
  v_cvt_pk_bf16_f32 v61, v54, v55
  v_mfma_f32_16x16x32_bf16 v[52:55], v[88:91], v[44:47], 0
  v_cvt_pk_bf16_f32 v50, v32, v33
  v_cvt_pk_bf16_f32 v51, v34, v35
  v_mfma_f32_16x16x32_bf16 v[32:35], v[24:27], v[112:115], 0
  v_cvt_pk_bf16_f32 v48, v64, v65
  v_cvt_pk_bf16_f32 v49, v66, v67
  v_mfma_f32_16x16x32_bf16 v[64:67], v[16:19], v[112:115], 0
  ds_write_b64 v68, v[60:61] offset:4608
  ds_read_b32 v71, v70 offset:8192
  v_mfma_f32_16x16x32_bf16 v[52:55], v[92:95], v[48:51], v[52:55]
  v_cvt_pk_bf16_f32 v44, v36, v37
  v_cvt_pk_bf16_f32 v45, v38, v39
  v_mfma_f32_16x16x32_bf16 v[32:35], v[28:31], v[116:119], v[32:35]
  v_cvt_pk_bf16_f32 v46, v40, v41
  v_cvt_pk_bf16_f32 v47, v42, v43
  v_mfma_f32_16x16x32_bf16 v[64:67], v[20:23], v[116:119], v[64:67]
  v_mfma_f32_16x16x32_bf16 v[36:39], v[0:3], v[104:107], 0
  s_nop 0
  v_cndmask_b32_dpp v52, v56, v52, vcc row_ror:8 row_mask:0xf bank_mask:0xf
  v_mfma_f32_16x16x32_bf16 v[40:43], v[8:11], v[104:107], 0
  v_cndmask_b32_dpp v53, v57, v53, vcc row_ror:8 row_mask:0xf bank_mask:0xf
  v_cvt_pk_bf16_f32 v50, v32, v33
  v_mfma_f32_16x16x32_bf16 v[36:39], v[4:7], v[108:111], v[36:39]
  v_cndmask_b32_dpp v54, v58, v54, vcc row_ror:8 row_mask:0xf bank_mask:0xf
  v_max3_f32 v60, v52, v53, v54
  v_mfma_f32_16x16x32_bf16 v[40:43], v[12:15], v[108:111], v[40:43]
  v_cndmask_b32_dpp v55, v59, v55, vcc row_ror:8 row_mask:0xf bank_mask:0xf
  v_max_f32 v60, v60, v55
  v_mfma_f32_16x16x32_bf16 v[56:59], v[112:115], v[44:47], 0
  v_mov_b32 v61, v60
  v_cvt_pk_bf16_f32 v51, v34, v35
  v_mfma_f32_16x16x32_bf16 v[32:35], v[24:27], v[104:107], 0
  v_permlane16_swap_b32 v61, v60
  v_mfma_f32_16x16x32_bf16 v[32:35], v[28:31], v[108:111], v[32:35]
  v_max_f32 v60, v60, v61
  v_sub_f32 v52, v52, v60
  v_sub_f32 v53, v53, v60
  v_sub_f32 v54, v54, v60
  v_sub_f32 v55, v55, v60
  v_exp_f32 v52, v52
  v_exp_f32 v53, v53
  v_exp_f32 v54, v54
  v_exp_f32 v55, v55
  v_cvt_pk_bf16_f32 v48, v64, v65
  v_cvt_pk_bf16_f32 v49, v66, v67
  v_mfma_f32_16x16x32_bf16 v[64:67], v[16:19], v[104:107], 0
  v_add_f32 v60, v52, v53
  v_add_f32 v61, v54, v55
  v_mfma_f32_16x16x32_bf16 v[64:67], v[20:23], v[108:111], v[64:67]
  v_add_f32 v60, v60, v61
  v_mov_b32 v61, v60
  v_mfma_f32_16x16x32_bf16 v[56:59], v[116:119], v[48:51], v[56:59]
  v_cvt_pk_bf16_f32 v44, v36, v37
  v_permlane16_swap_b32 v61, v60
  v_add_f32 v60, v60, v61
  s_waitcnt lgkmcnt(0)
  v_mul_f32 v60, v60, v71
  v_rcp_f32 v60, v60
  v_cvt_pk_bf16_f32 v45, v38, v39
  v_mfma_f32_16x16x32_bf16 v[36:39], v[0:3], v[120:123], 0
  v_cvt_pk_bf16_f32 v46, v40, v41
  v_cvt_pk_bf16_f32 v47, v42, v43
  v_mfma_f32_16x16x32_bf16 v[40:43], v[8:11], v[120:123], 0
  v_mul_f32 v52, v52, v60
  v_mul_f32 v53, v53, v60
  v_mfma_f32_16x16x32_bf16 v[36:39], v[4:7], v[124:127], v[36:39]
  v_mul_f32 v54, v54, v60
  v_mul_f32 v55, v55, v60
  v_mfma_f32_16x16x32_bf16 v[40:43], v[12:15], v[124:127], v[40:43]
  v_cvt_pk_bf16_f32 v60, v52, v53
  v_cvt_pk_bf16_f32 v61, v54, v55
  v_mfma_f32_16x16x32_bf16 v[52:55], v[104:107], v[44:47], 0
  v_cvt_pk_bf16_f32 v50, v32, v33
  v_cvt_pk_bf16_f32 v51, v34, v35
  v_mfma_f32_16x16x32_bf16 v[32:35], v[24:27], v[120:123], 0
  v_cvt_pk_bf16_f32 v48, v64, v65
  v_cvt_pk_bf16_f32 v49, v66, v67
  v_mfma_f32_16x16x32_bf16 v[64:67], v[16:19], v[120:123], 0
  ds_write_b64 v68, v[60:61] offset:5376
  ds_read_b32 v71, v70 offset:8448
  v_mfma_f32_16x16x32_bf16 v[52:55], v[108:111], v[48:51], v[52:55]
  v_cvt_pk_bf16_f32 v44, v36, v37
  v_cvt_pk_bf16_f32 v45, v38, v39
  v_mfma_f32_16x16x32_bf16 v[32:35], v[28:31], v[124:127], v[32:35]
  v_cvt_pk_bf16_f32 v46, v40, v41
  v_cvt_pk_bf16_f32 v47, v42, v43
  v_mfma_f32_16x16x32_bf16 v[64:67], v[20:23], v[124:127], v[64:67]
  s_nop 1
  v_cndmask_b32_dpp v52, v56, v52, vcc row_ror:8 row_mask:0xf bank_mask:0xf
  s_nop 1
  v_cvt_pk_bf16_f32 v50, v32, v33
  v_cndmask_b32_dpp v53, v57, v53, vcc row_ror:8 row_mask:0xf bank_mask:0xf
  v_cvt_pk_bf16_f32 v51, v34, v35
  v_cndmask_b32_dpp v54, v58, v54, vcc row_ror:8 row_mask:0xf bank_mask:0xf
  v_max3_f32 v60, v52, v53, v54
  v_cndmask_b32_dpp v55, v59, v55, vcc row_ror:8 row_mask:0xf bank_mask:0xf
  v_max_f32 v60, v60, v55
  v_mov_b32 v61, v60
  v_cvt_pk_bf16_f32 v48, v64, v65
  v_cvt_pk_bf16_f32 v49, v66, v67
  v_permlane16_swap_b32 v61, v60
  v_max_f32 v60, v60, v61
  v_sub_f32 v52, v52, v60
  v_sub_f32 v53, v53, v60
  v_sub_f32 v54, v54, v60
  v_sub_f32 v55, v55, v60
  v_exp_f32 v52, v52
  v_exp_f32 v53, v53
  v_exp_f32 v54, v54
  v_exp_f32 v55, v55
  v_add_f32 v60, v52, v53
  v_add_f32 v61, v54, v55
  v_add_f32 v60, v60, v61
  v_mov_b32 v61, v60
  s_nop 1
  v_permlane16_swap_b32 v61, v60
  v_add_f32 v60, v60, v61
  s_waitcnt lgkmcnt(0)
  v_mul_f32 v60, v60, v71
  v_rcp_f32 v60, v60
  s_nop 0
  v_mul_f32 v52, v52, v60
  v_mul_f32 v53, v53, v60
  v_mul_f32 v54, v54, v60
  v_mul_f32 v55, v55, v60
  v_cvt_pk_bf16_f32 v60, v52, v53
  v_cvt_pk_bf16_f32 v61, v54, v55
  v_mfma_f32_16x16x32_bf16 v[52:55], v[120:123], v[44:47], 0
  ds_write_b64 v68, v[60:61] offset:6144
  ds_read_b32 v71, v70 offset:8704
  v_mfma_f32_16x16x32_bf16 v[52:55], v[124:127], v[48:51], v[52:55]
  ds_read_b128 v[24:27], v69 offset:14336
  ds_read_b128 v[28:31], v69 offset:15360
  ds_read_b128 v[0:3], v69 offset:8192
  ds_read_b128 v[4:7], v69 offset:9216
  ds_read_b128 v[8:11], v69 offset:10240
  ds_read_b128 v[12:15], v69 offset:11264
  ds_read_b128 v[16:19], v69 offset:12288
  ds_read_b128 v[20:23], v69 offset:13312
  v_max3_f32 v60, v52, v53, v54
  ds_read_b128 v[56:59], v69 offset:18432
  v_max_f32 v60, v60, v55
  v_mov_b32 v61, v60
  ds_read_b128 v[44:47], v69 offset:16384
  ds_read_b128 v[48:51], v69 offset:17408
  v_permlane16_swap_b32 v61, v60
  v_max_f32 v60, v60, v61
  v_sub_f32 v52, v52, v60
  v_sub_f32 v53, v53, v60
  v_sub_f32 v54, v54, v60
  v_sub_f32 v55, v55, v60
  v_exp_f32 v52, v52
  v_exp_f32 v53, v53
  s_waitcnt lgkmcnt(10)
  v_mfma_f32_16x16x32_bf16 v[64:67], v[72:75], v[24:27], 0
  v_exp_f32 v54, v54
  s_waitcnt lgkmcnt(8)
  v_mfma_f32_16x16x32_bf16 v[32:35], v[72:75], v[0:3], 0
  v_exp_f32 v55, v55
  s_waitcnt lgkmcnt(7)
  v_mfma_f32_16x16x32_bf16 v[32:35], v[76:79], v[4:7], v[32:35]
  v_add_f32 v60, v52, v53
  v_add_f32 v61, v54, v55
  s_waitcnt lgkmcnt(6)
  v_mfma_f32_16x16x32_bf16 v[36:39], v[72:75], v[8:11], 0
  v_add_f32 v60, v60, v61
  v_mov_b32 v61, v60
  s_waitcnt lgkmcnt(5)
  v_mfma_f32_16x16x32_bf16 v[36:39], v[76:79], v[12:15], v[36:39]
  s_waitcnt lgkmcnt(2)
  v_mad_u32_u16 v63, v58, 4, s52 op_sel:[0,0,0,0]
  v_permlane16_swap_b32 v61, v60
  v_mfma_f32_16x16x32_bf16 v[40:43], v[72:75], v[16:19], 0
  v_add_f32 v60, v60, v61
  v_mul_f32 v60, v60, v71
  v_mfma_f32_16x16x32_bf16 v[40:43], v[76:79], v[20:23], v[40:43]
  v_rcp_f32 v60, v60
  v_mfma_f32_16x16x32_bf16 v[64:67], v[76:79], v[28:31], v[64:67]
  v_mul_f32 v52, v52, v60
  v_mul_f32 v53, v53, v60
  v_mul_f32 v54, v54, v60
  v_mul_f32 v55, v55, v60
  v_cvt_pk_bf16_f32 v60, v52, v53
  v_cvt_pk_bf16_f32 v61, v54, v55
  ds_write_b64 v68, v[60:61] offset:6912
  ds_read_b64 v[70:71], v63
  v_cndmask_b32 v54, 0, v59, s[64:65]
  v_cndmask_b32 v55, v59, 0, s[64:65]
  v_cvt_pk_bf16_f32 v52, v32, v33
  v_cvt_pk_bf16_f32 v53, v34, v35
  v_mad_u32_u16 v60, v56, 4, s52 op_sel:[1,0,0,0]
  v_mad_u32_u16 v61, v57, 4, s52 op_sel:[0,0,0,0]
  v_mad_u32_u16 v62, v57, 4, s52 op_sel:[1,0,0,0]
  v_mad_u32_u16 v68, v58, 4, s52 op_sel:[1,0,0,0]
  v_mov_b64 v[58:59], v[54:55]
  v_cvt_pk_bf16_f32 v56, v36, v37
  v_cvt_pk_bf16_f32 v57, v38, v39
  s_waitcnt lgkmcnt(0)
  v_mfma_f32_16x16x32_bf16 v[32:35], v[52:55], v[70:73], 0
  v_mov_b64 v[72:73], v[70:71]
  v_cvt_pk_bf16_f32 v52, v40, v41
  v_cvt_pk_bf16_f32 v53, v42, v43
  v_mfma_f32_16x16x32_bf16 v[36:39], v[56:59], v[72:75], 0
  v_mov_b64 v[74:75], v[72:73]
  v_cvt_pk_bf16_f32 v56, v64, v65
  v_cvt_pk_bf16_f32 v57, v66, v67
  v_mfma_f32_16x16x32_bf16 v[40:43], v[52:55], v[74:77], 0
  v_mov_b64 v[76:77], v[74:75]
  v_cvt_pk_bf16_f32 v70, v32, v33
  v_cvt_pk_bf16_f32 v71, v34, v35
  v_mfma_f32_16x16x32_bf16 v[64:67], v[56:59], v[76:79], 0
  ds_read_b64 v[78:79], v68 offset:0
  v_cvt_pk_bf16_f32 v72, v36, v37
  v_mfma_f32_16x16x32_bf16 v[32:35], v[80:83], v[0:3], 0
  v_cvt_pk_bf16_f32 v73, v38, v39
  v_cvt_pk_bf16_f32 v74, v40, v41
  v_mfma_f32_16x16x32_bf16 v[32:35], v[84:87], v[4:7], v[32:35]
  v_cvt_pk_bf16_f32 v75, v42, v43
  ds_write_b128 v60, v[70:73] offset:0
  v_mfma_f32_16x16x32_bf16 v[40:43], v[70:73], v[70:73], 0
  v_cvt_pk_bf16_f32 v76, v64, v65
  v_cvt_pk_bf16_f32 v77, v66, v67
  v_mfma_f32_16x16x32_bf16 v[64:67], v[44:47], v[70:73], 0
  ds_write_b128 v60, v[74:77] offset:1024
  v_mfma_f32_16x16x32_bf16 v[40:43], v[74:77], v[74:77], v[40:43]
  v_cvt_pk_bf16_f32 v52, v32, v33
  v_cvt_pk_bf16_f32 v53, v34, v35
  v_mfma_f32_16x16x32_bf16 v[64:67], v[48:51], v[74:77], v[64:67]
  v_mfma_f32_16x16x32_bf16 v[36:39], v[80:83], v[8:11], 0
  v_mfma_f32_16x16x32_bf16 v[36:39], v[84:87], v[12:15], v[36:39]
  s_waitcnt lgkmcnt(2)
  v_mfma_f32_16x16x32_bf16 v[32:35], v[52:55], v[78:81], 0
  s_nop 3
  v_cndmask_b32 v66, v42, v40, s[64:65]
  v_cndmask_b32 v67, v43, v41, s[64:65]
  v_mfma_f32_16x16x32_bf16 v[40:43], v[80:83], v[16:19], 0
  ds_write_b128 v62, v[64:67] offset:0
  v_cvt_pk_bf16_f32 v56, v36, v37
  v_mfma_f32_16x16x32_bf16 v[40:43], v[84:87], v[20:23], v[40:43]
  v_cvt_pk_bf16_f32 v57, v38, v39
  v_mfma_f32_16x16x32_bf16 v[64:67], v[80:83], v[24:27], 0
  v_mov_b64 v[80:81], v[78:79]
  v_cvt_pk_bf16_f32 v78, v32, v33
  v_mfma_f32_16x16x32_bf16 v[64:67], v[84:87], v[28:31], v[64:67]
  v_cvt_pk_bf16_f32 v79, v34, v35
  v_mfma_f32_16x16x32_bf16 v[36:39], v[56:59], v[80:83], 0
  v_mov_b64 v[82:83], v[80:81]
  v_cvt_pk_bf16_f32 v52, v40, v41
  v_mfma_f32_16x16x32_bf16 v[32:35], v[88:91], v[0:3], 0
  v_cvt_pk_bf16_f32 v53, v42, v43
  v_mfma_f32_16x16x32_bf16 v[32:35], v[92:95], v[4:7], v[32:35]
  s_nop 0
  v_cvt_pk_bf16_f32 v56, v64, v65
  v_mfma_f32_16x16x32_bf16 v[40:43], v[52:55], v[82:85], 0
  v_mov_b64 v[84:85], v[82:83]
  v_cvt_pk_bf16_f32 v57, v66, v67
  v_cvt_pk_bf16_f32 v80, v36, v37
  v_cvt_pk_bf16_f32 v81, v38, v39
  v_mfma_f32_16x16x32_bf16 v[64:67], v[56:59], v[84:87], 0
  ds_read_b64 v[86:87], v63 offset:768
  ds_write_b128 v60, v[78:81] offset:2048
  v_mfma_f32_16x16x32_bf16 v[36:39], v[88:91], v[8:11], 0
  v_cvt_pk_bf16_f32 v82, v40, v41
  v_cvt_pk_bf16_f32 v83, v42, v43
  v_mfma_f32_16x16x32_bf16 v[40:43], v[78:81], v[78:81], 0
  v_cvt_pk_bf16_f32 v52, v32, v33
  v_cvt_pk_bf16_f32 v53, v34, v35
  v_mfma_f32_16x16x32_bf16 v[36:39], v[92:95], v[12:15], v[36:39]
  v_cvt_pk_bf16_f32 v84, v64, v65
  v_cvt_pk_bf16_f32 v85, v66, v67
  v_mfma_f32_16x16x32_bf16 v[64:67], v[44:47], v[78:81], 0
  ds_write_b128 v60, v[82:85] offset:3072
  ds_read_b64_tr_b16 v[70:71], v61 offset:0
  v_mfma_f32_16x16x32_bf16 v[40:43], v[82:85], v[82:85], v[40:43]
  ds_read_b64_tr_b16 v[74:75], v61 offset:512
  ds_read_b64_tr_b16 v[78:79], v61 offset:1024
  v_mfma_f32_16x16x32_bf16 v[64:67], v[48:51], v[82:85], v[64:67]
  ds_read_b64_tr_b16 v[82:83], v61 offset:1536
  ds_read_b64_tr_b16 v[72:73], v61 offset:2048
  s_waitcnt lgkmcnt(7)
  v_mfma_f32_16x16x32_bf16 v[32:35], v[52:55], v[86:89], 0
  ds_read_b64_tr_b16 v[76:77], v61 offset:2560
  ds_read_b64_tr_b16 v[80:81], v61 offset:3072
  ds_read_b64_tr_b16 v[84:85], v61 offset:3584
  v_cvt_pk_bf16_f32 v56, v36, v37
  v_cvt_pk_bf16_f32 v57, v38, v39
  v_cndmask_b32 v66, v42, v40, s[64:65]
  v_cndmask_b32 v67, v43, v41, s[64:65]
  v_mfma_f32_16x16x32_bf16 v[40:43], v[88:91], v[16:19], 0
  ds_write_b128 v62, v[64:67] offset:384
  v_mfma_f32_16x16x32_bf16 v[40:43], v[92:95], v[20:23], v[40:43]
  v_mfma_f32_16x16x32_bf16 v[64:67], v[88:91], v[24:27], 0
  v_mov_b64 v[88:89], v[86:87]
  v_cvt_pk_bf16_f32 v86, v32, v33
  v_mfma_f32_16x16x32_bf16 v[64:67], v[92:95], v[28:31], v[64:67]
  v_cvt_pk_bf16_f32 v87, v34, v35
  v_mfma_f32_16x16x32_bf16 v[36:39], v[56:59], v[88:91], 0
  v_mov_b64 v[90:91], v[88:89]
  v_mfma_f32_16x16x32_bf16 v[32:35], v[96:99], v[0:3], 0
  v_cvt_pk_bf16_f32 v52, v40, v41
  v_cvt_pk_bf16_f32 v53, v42, v43
  v_mfma_f32_16x16x32_bf16 v[32:35], v[100:103], v[4:7], v[32:35]
  s_nop 0
  v_cvt_pk_bf16_f32 v56, v64, v65
  v_mfma_f32_16x16x32_bf16 v[40:43], v[52:55], v[90:93], 0
  v_mov_b64 v[92:93], v[90:91]
  v_cvt_pk_bf16_f32 v57, v66, v67
  v_cvt_pk_bf16_f32 v88, v36, v37
  v_cvt_pk_bf16_f32 v89, v38, v39
  v_mfma_f32_16x16x32_bf16 v[64:67], v[56:59], v[92:95], 0
  ds_read_b64 v[94:95], v68 offset:768
  ds_write_b128 v60, v[86:89] offset:0
  v_mfma_f32_16x16x32_bf16 v[36:39], v[96:99], v[8:11], 0
  v_cvt_pk_bf16_f32 v90, v40, v41
  v_cvt_pk_bf16_f32 v91, v42, v43
  v_mfma_f32_16x16x32_bf16 v[40:43], v[86:89], v[86:89], 0
  v_cvt_pk_bf16_f32 v52, v32, v33
  v_cvt_pk_bf16_f32 v53, v34, v35
  v_mfma_f32_16x16x32_bf16 v[36:39], v[100:103], v[12:15], v[36:39]
  v_cvt_pk_bf16_f32 v92, v64, v65
  v_cvt_pk_bf16_f32 v93, v66, v67
  v_mfma_f32_16x16x32_bf16 v[64:67], v[44:47], v[86:89], 0
  ds_write_b128 v60, v[90:93] offset:1024
  v_mfma_f32_16x16x32_bf16 v[40:43], v[90:93], v[90:93], v[40:43]
  v_mfma_f32_16x16x32_bf16 v[64:67], v[48:51], v[90:93], v[64:67]
  s_waitcnt lgkmcnt(2)
  v_mfma_f32_16x16x32_bf16 v[32:35], v[52:55], v[94:97], 0
  v_cvt_pk_bf16_f32 v56, v36, v37
  v_cvt_pk_bf16_f32 v57, v38, v39
  s_nop 3
  v_cndmask_b32 v66, v42, v40, s[64:65]
  v_cndmask_b32 v67, v43, v41, s[64:65]
  v_mfma_f32_16x16x32_bf16 v[40:43], v[96:99], v[16:19], 0
  ds_write_b128 v62, v[64:67] offset:768
  v_mfma_f32_16x16x32_bf16 v[40:43], v[100:103], v[20:23], v[40:43]
  v_mfma_f32_16x16x32_bf16 v[64:67], v[96:99], v[24:27], 0
  v_mov_b64 v[96:97], v[94:95]
  v_cvt_pk_bf16_f32 v94, v32, v33
  v_mfma_f32_16x16x32_bf16 v[64:67], v[100:103], v[28:31], v[64:67]
  v_cvt_pk_bf16_f32 v95, v34, v35
  v_mfma_f32_16x16x32_bf16 v[36:39], v[56:59], v[96:99], 0
  v_mov_b64 v[98:99], v[96:97]
  v_mfma_f32_16x16x32_bf16 v[32:35], v[104:107], v[0:3], 0
  v_cvt_pk_bf16_f32 v52, v40, v41
  v_cvt_pk_bf16_f32 v53, v42, v43
  v_mfma_f32_16x16x32_bf16 v[32:35], v[108:111], v[4:7], v[32:35]
  s_nop 0
  v_cvt_pk_bf16_f32 v56, v64, v65
  v_mfma_f32_16x16x32_bf16 v[40:43], v[52:55], v[98:101], 0
  v_mov_b64 v[100:101], v[98:99]
  v_cvt_pk_bf16_f32 v57, v66, v67
  v_cvt_pk_bf16_f32 v96, v36, v37
  v_cvt_pk_bf16_f32 v97, v38, v39
  v_mfma_f32_16x16x32_bf16 v[64:67], v[56:59], v[100:103], 0
  ds_read_b64 v[102:103], v63 offset:1536
  ds_write_b128 v60, v[94:97] offset:2048
  v_mfma_f32_16x16x32_bf16 v[36:39], v[104:107], v[8:11], 0
  v_cvt_pk_bf16_f32 v98, v40, v41
  v_cvt_pk_bf16_f32 v99, v42, v43
  v_mfma_f32_16x16x32_bf16 v[40:43], v[94:97], v[94:97], 0
  v_cvt_pk_bf16_f32 v52, v32, v33
  v_cvt_pk_bf16_f32 v53, v34, v35
  v_mfma_f32_16x16x32_bf16 v[36:39], v[108:111], v[12:15], v[36:39]
  v_cvt_pk_bf16_f32 v100, v64, v65
  v_cvt_pk_bf16_f32 v101, v66, v67
  v_mfma_f32_16x16x32_bf16 v[64:67], v[44:47], v[94:97], 0
  ds_write_b128 v60, v[98:101] offset:3072
  ds_read_b64_tr_b16 v[86:87], v61 offset:0
  v_mfma_f32_16x16x32_bf16 v[40:43], v[98:101], v[98:101], v[40:43]
  ds_read_b64_tr_b16 v[90:91], v61 offset:512
  ds_read_b64_tr_b16 v[94:95], v61 offset:1024
  v_mfma_f32_16x16x32_bf16 v[64:67], v[48:51], v[98:101], v[64:67]
  ds_read_b64_tr_b16 v[98:99], v61 offset:1536
  ds_read_b64_tr_b16 v[88:89], v61 offset:2048
  s_waitcnt lgkmcnt(7)
  v_mfma_f32_16x16x32_bf16 v[32:35], v[52:55], v[102:105], 0
  ds_read_b64_tr_b16 v[92:93], v61 offset:2560
  ds_read_b64_tr_b16 v[96:97], v61 offset:3072
  ds_read_b64_tr_b16 v[100:101], v61 offset:3584
  v_cvt_pk_bf16_f32 v56, v36, v37
  v_cvt_pk_bf16_f32 v57, v38, v39
  v_cndmask_b32 v66, v42, v40, s[64:65]
  v_cndmask_b32 v67, v43, v41, s[64:65]
  v_mfma_f32_16x16x32_bf16 v[40:43], v[104:107], v[16:19], 0
  ds_write_b128 v62, v[64:67] offset:1152
  v_mfma_f32_16x16x32_bf16 v[40:43], v[108:111], v[20:23], v[40:43]
  v_mfma_f32_16x16x32_bf16 v[64:67], v[104:107], v[24:27], 0
  v_mov_b64 v[104:105], v[102:103]
  v_cvt_pk_bf16_f32 v102, v32, v33
  v_mfma_f32_16x16x32_bf16 v[64:67], v[108:111], v[28:31], v[64:67]
  v_cvt_pk_bf16_f32 v103, v34, v35
  v_mfma_f32_16x16x32_bf16 v[36:39], v[56:59], v[104:107], 0
  v_mov_b64 v[106:107], v[104:105]
  v_mfma_f32_16x16x32_bf16 v[32:35], v[112:115], v[0:3], 0
  v_cvt_pk_bf16_f32 v52, v40, v41
  v_cvt_pk_bf16_f32 v53, v42, v43
  v_mfma_f32_16x16x32_bf16 v[32:35], v[116:119], v[4:7], v[32:35]
  s_nop 0
  v_cvt_pk_bf16_f32 v56, v64, v65
  v_mfma_f32_16x16x32_bf16 v[40:43], v[52:55], v[106:109], 0
  v_mov_b64 v[108:109], v[106:107]
  v_cvt_pk_bf16_f32 v57, v66, v67
  v_cvt_pk_bf16_f32 v104, v36, v37
  v_cvt_pk_bf16_f32 v105, v38, v39
  v_mfma_f32_16x16x32_bf16 v[64:67], v[56:59], v[108:111], 0
  ds_read_b64 v[110:111], v68 offset:1536
  ds_write_b128 v60, v[102:105] offset:0
  v_mfma_f32_16x16x32_bf16 v[36:39], v[112:115], v[8:11], 0
  v_cvt_pk_bf16_f32 v106, v40, v41
  v_cvt_pk_bf16_f32 v107, v42, v43
  v_mfma_f32_16x16x32_bf16 v[40:43], v[102:105], v[102:105], 0
  v_cvt_pk_bf16_f32 v52, v32, v33
  v_cvt_pk_bf16_f32 v53, v34, v35
  v_mfma_f32_16x16x32_bf16 v[36:39], v[116:119], v[12:15], v[36:39]
  v_cvt_pk_bf16_f32 v108, v64, v65
  v_cvt_pk_bf16_f32 v109, v66, v67
  v_mfma_f32_16x16x32_bf16 v[64:67], v[44:47], v[102:105], 0
  ds_write_b128 v60, v[106:109] offset:1024
  v_mfma_f32_16x16x32_bf16 v[40:43], v[106:109], v[106:109], v[40:43]
  v_mfma_f32_16x16x32_bf16 v[64:67], v[48:51], v[106:109], v[64:67]
  s_waitcnt lgkmcnt(2)
  v_mfma_f32_16x16x32_bf16 v[32:35], v[52:55], v[110:113], 0
  v_cvt_pk_bf16_f32 v56, v36, v37
  v_cvt_pk_bf16_f32 v57, v38, v39
  s_nop 3
  v_cndmask_b32 v66, v42, v40, s[64:65]
  v_cndmask_b32 v67, v43, v41, s[64:65]
  v_mfma_f32_16x16x32_bf16 v[40:43], v[112:115], v[16:19], 0
  ds_write_b128 v62, v[64:67] offset:1536
  v_mfma_f32_16x16x32_bf16 v[40:43], v[116:119], v[20:23], v[40:43]
  v_mfma_f32_16x16x32_bf16 v[64:67], v[112:115], v[24:27], 0
  v_mov_b64 v[112:113], v[110:111]
  v_cvt_pk_bf16_f32 v110, v32, v33
  v_mfma_f32_16x16x32_bf16 v[64:67], v[116:119], v[28:31], v[64:67]
  v_cvt_pk_bf16_f32 v111, v34, v35
  v_mfma_f32_16x16x32_bf16 v[36:39], v[56:59], v[112:115], 0
  v_mov_b64 v[114:115], v[112:113]
  v_mfma_f32_16x16x32_bf16 v[32:35], v[120:123], v[0:3], 0
  v_cvt_pk_bf16_f32 v52, v40, v41
  v_cvt_pk_bf16_f32 v53, v42, v43
  v_mfma_f32_16x16x32_bf16 v[32:35], v[124:127], v[4:7], v[32:35]
  s_nop 0
  v_cvt_pk_bf16_f32 v56, v64, v65
  v_mfma_f32_16x16x32_bf16 v[40:43], v[52:55], v[114:117], 0
  v_mov_b64 v[116:117], v[114:115]
  v_cvt_pk_bf16_f32 v57, v66, v67
  v_cvt_pk_bf16_f32 v112, v36, v37
  v_cvt_pk_bf16_f32 v113, v38, v39
  v_mfma_f32_16x16x32_bf16 v[64:67], v[56:59], v[116:119], 0
  ds_read_b64 v[118:119], v63 offset:2304
  ds_write_b128 v60, v[110:113] offset:2048
  v_mfma_f32_16x16x32_bf16 v[36:39], v[120:123], v[8:11], 0
  v_cvt_pk_bf16_f32 v114, v40, v41
  v_cvt_pk_bf16_f32 v115, v42, v43
  v_mfma_f32_16x16x32_bf16 v[40:43], v[110:113], v[110:113], 0
  v_cvt_pk_bf16_f32 v52, v32, v33
  v_cvt_pk_bf16_f32 v53, v34, v35
  v_mfma_f32_16x16x32_bf16 v[36:39], v[124:127], v[12:15], v[36:39]
  v_cvt_pk_bf16_f32 v116, v64, v65
  v_cvt_pk_bf16_f32 v117, v66, v67
  v_mfma_f32_16x16x32_bf16 v[64:67], v[44:47], v[110:113], 0
  ds_write_b128 v60, v[114:117] offset:3072
  ds_read_b64_tr_b16 v[102:103], v61 offset:0
  v_mfma_f32_16x16x32_bf16 v[40:43], v[114:117], v[114:117], v[40:43]
  ds_read_b64_tr_b16 v[106:107], v61 offset:512
  ds_read_b64_tr_b16 v[110:111], v61 offset:1024
  v_mfma_f32_16x16x32_bf16 v[64:67], v[48:51], v[114:117], v[64:67]
  ds_read_b64_tr_b16 v[114:115], v61 offset:1536
  ds_read_b64_tr_b16 v[104:105], v61 offset:2048
  s_waitcnt lgkmcnt(7)
  v_mfma_f32_16x16x32_bf16 v[32:35], v[52:55], v[118:121], 0
  ds_read_b64_tr_b16 v[108:109], v61 offset:2560
  ds_read_b64_tr_b16 v[112:113], v61 offset:3072
  ds_read_b64_tr_b16 v[116:117], v61 offset:3584
  v_cvt_pk_bf16_f32 v56, v36, v37
  v_cvt_pk_bf16_f32 v57, v38, v39
  v_cndmask_b32 v66, v42, v40, s[64:65]
  v_cndmask_b32 v67, v43, v41, s[64:65]
  v_mfma_f32_16x16x32_bf16 v[40:43], v[120:123], v[16:19], 0
  ds_write_b128 v62, v[64:67] offset:1920
  v_mfma_f32_16x16x32_bf16 v[40:43], v[124:127], v[20:23], v[40:43]
  v_lshrrev_b32 v23, 1, v69
  v_add_u32 v23, s56, v23
  v_mfma_f32_16x16x32_bf16 v[64:67], v[120:123], v[24:27], 0
  v_mov_b64 v[120:121], v[118:119]
  v_cvt_pk_bf16_f32 v118, v32, v33
  v_mfma_f32_16x16x32_bf16 v[64:67], v[124:127], v[28:31], v[64:67]
  v_cvt_pk_bf16_f32 v119, v34, v35
  v_mov_b32 v26, 2147483648
  v_mfma_f32_16x16x32_bf16 v[36:39], v[56:59], v[120:123], 0
  v_mov_b64 v[122:123], v[120:121]
  v_cvt_pk_bf16_f32 v52, v40, v41
  v_cvt_pk_bf16_f32 v53, v42, v43
  s_nop 1
  v_mfma_f32_16x16x32_bf16 v[40:43], v[52:55], v[122:125], 0
  v_mov_b64 v[124:125], v[122:123]
  v_cvt_pk_bf16_f32 v56, v64, v65
  v_cvt_pk_bf16_f32 v57, v66, v67
  v_cvt_pk_bf16_f32 v120, v36, v37
  v_cvt_pk_bf16_f32 v121, v38, v39
  v_mfma_f32_16x16x32_bf16 v[64:67], v[56:59], v[124:127], 0
  ds_write_b128 v60, v[118:121] offset:0
  s_nop 0
  v_cvt_pk_bf16_f32 v122, v40, v41
  v_cvt_pk_bf16_f32 v123, v42, v43
  v_mfma_f32_16x16x32_bf16 v[40:43], v[118:121], v[118:121], 0
  s_nop 2
  v_cvt_pk_bf16_f32 v124, v64, v65
  v_cvt_pk_bf16_f32 v125, v66, v67
  v_mfma_f32_16x16x32_bf16 v[64:67], v[44:47], v[118:121], 0
  ds_write_b128 v60, v[122:125] offset:1024
  ds_read_b64_tr_b16 v[118:119], v61 offset:0
  v_mfma_f32_16x16x32_bf16 v[40:43], v[122:125], v[122:125], v[40:43]
  ds_read_b64_tr_b16 v[120:121], v61 offset:512
  v_mov_b64 v[44:45], 0
  v_mfma_f32_16x16x32_bf16 v[64:67], v[48:51], v[122:125], v[64:67]
  ds_read_b64_tr_b16 v[122:123], v61 offset:1024
  ds_read_b64_tr_b16 v[124:125], v61 offset:1536
  s_nop 5
  v_cndmask_b32 v66, v42, v40, s[64:65]
  v_cndmask_b32 v67, v43, v41, s[64:65]
  ds_write_b128 v62, v[64:67] offset:2304
  ds_read_b128 v[28:31], v69 offset:19456
  ds_write_b64 v23, v[44:45] offset:16
  s_waitcnt lgkmcnt(1)
  v_mad_u32_u16 v17, v28, 4, s52 op_sel:[1,0,0,0]
  v_mad_u32_u16 v16, v28, 4, s52 op_sel:[0,0,0,0]
  ds_read_b32 v0, v17 offset:0
  ds_read_b64 v[2:3], v16 offset:0
  ds_read_b64 v[4:5], v23 offset:7936
  ds_read_b32 v8, v17 offset:1536
  ds_read_b64 v[10:11], v16 offset:1536
  ds_read_b64 v[12:13], v23 offset:8448
  v_mad_u32_u16 v18, v29, 2, s52 op_sel:[0,0,0,0]
  v_mad_u32_u16 v20, v30, 4, s52 op_sel:[0,0,0,0]
  v_mad_u32_u16 v19, v29, 4, s52 op_sel:[1,0,0,0]
  v_mad_u32_u16 v21, v30, 4, s52 op_sel:[1,0,0,0]
  v_cndmask_b32 v48, v26, v19, s[14:15]
  v_cndmask_b32 v49, v26, v19, s[16:17]
  v_cndmask_b32 v50, v26, v19, s[18:19]
  v_cndmask_b32 v51, v26, v19, s[20:21]
  v_mad_u32_u16 v22, v31, 4, s52 op_sel:[0,0,0,0]
  v_mad_u32_u16 v24, v31, 16, s59 op_sel:[1,0,0,0]
  v_mad_u32_u16 v25, v31, 16, s58 op_sel:[1,0,0,0]
  s_nop 1
  v_mov_b32_dpp v25, v26 quad_perm:[0,1,2,3] row_mask:8 bank_mask:0xf
  s_waitcnt lgkmcnt(5)
  v_mul_f32 v0, 0x3c800000, v0
  s_waitcnt lgkmcnt(4)
  v_fma_f32 v0, -v2, v2, v0
  v_max_f32 v0, 0, v0
  s_waitcnt lgkmcnt(3)
  v_mul_f32 v1, v4, v4
  s_waitcnt lgkmcnt(2)
  v_mul_f32 v8, 0x3c800000, v8
  v_fma_f32 v0, v1, v0, s13
  s_waitcnt lgkmcnt(1)
  v_fma_f32 v8, -v10, v10, v8
  v_rsq_f32 v0, v0
  v_fma_f32 v3, -v2, s12, v3
  v_mul_f32 v1, 0x3fb8aa3b, v4
  v_max_f32 v8, 0, v8
  s_waitcnt lgkmcnt(0)
  v_mul_f32 v9, v12, v12
  v_mul_f32 v3, v3, v1
  v_fma_f32 v8, v9, v8, s13
  v_mul_f32 v3, v3, v0
  v_rsq_f32 v8, v8
  v_fma_f32 v11, -v10, s12, v11
  v_mul_f32 v9, 0x3fb8aa3b, v12
  v_mul_f32 v11, v11, v9
  v_mul_f32 v11, v11, v8
  v_max_f32_dpp v1, v3, v3 quad_perm:[1,0,3,2] row_mask:0xf bank_mask:0xf
  s_nop 0
  v_max_f32_dpp v9, v11, v11 quad_perm:[1,0,3,2] row_mask:0xf bank_mask:0xf
  v_max_f32_dpp v1, v1, v1 quad_perm:[2,3,0,1] row_mask:0xf bank_mask:0xf
  s_nop 0
  v_max_f32_dpp v9, v9, v9 quad_perm:[2,3,0,1] row_mask:0xf bank_mask:0xf
  v_max_f32_dpp v1, v1, v1 row_half_mirror row_mask:0xf bank_mask:0xf
  v_sub_f32 v3, v3, v1
  v_exp_f32 v3, v3
  v_max_f32_dpp v9, v9, v9 row_half_mirror row_mask:0xf bank_mask:0xf
  v_sub_f32 v11, v11, v9
  v_exp_f32 v11, v11
  v_add_f32_dpp v1, v3, v3 quad_perm:[1,0,3,2] row_mask:0xf bank_mask:0xf
  v_mul_f32 v5, v5, v3
  v_add_f32_dpp v9, v11, v11 quad_perm:[1,0,3,2] row_mask:0xf bank_mask:0xf
  v_add_f32_dpp v1, v1, v1 quad_perm:[2,3,0,1] row_mask:0xf bank_mask:0xf
  v_mul_f32 v13, v13, v11
  v_add_f32_dpp v5, v5, v5 quad_perm:[1,0,3,2] row_mask:0xf bank_mask:0xf
  v_add_f32_dpp v9, v9, v9 quad_perm:[2,3,0,1] row_mask:0xf bank_mask:0xf
  v_add_f32_dpp v1, v1, v1 row_half_mirror row_mask:0xf bank_mask:0xf
  v_add_f32_dpp v13, v13, v13 quad_perm:[1,0,3,2] row_mask:0xf bank_mask:0xf
  v_add_f32_dpp v5, v5, v5 quad_perm:[2,3,0,1] row_mask:0xf bank_mask:0xf
  v_rcp_f32 v1, v1
  v_mul_f32 v3, v3, v4
  v_add_f32_dpp v9, v9, v9 row_half_mirror row_mask:0xf bank_mask:0xf
  v_mul_f32 v3, v3, v1
  v_add_f32_dpp v13, v13, v13 quad_perm:[2,3,0,1] row_mask:0xf bank_mask:0xf
  v_rcp_f32 v9, v9
  v_add_f32_dpp v5, v5, v5 row_half_mirror row_mask:0xf bank_mask:0xf
  v_cvt_pk_bf16_f32 v3, v3, v3
  v_mul_f32 v11, v11, v12
  v_mul_f32 v5, v5, v1
  v_mul_f32 v11, v11, v9
  ds_write_b16 v18, v3 offset:16
  v_add_f32_dpp v13, v13, v13 row_half_mirror row_mask:0xf bank_mask:0xf
  v_cvt_pk_bf16_f32 v11, v11, v11
  ds_write_b32 v23, v5 offset:7936
  v_mul_f32 v13, v13, v9
  ds_write_b16 v18, v11 offset:272
  ds_write_b32 v23, v13 offset:8448
  ds_read_b32 v28, v20 offset:7936
  ds_read_b128 v[32:35], v48
  ds_read_b128 v[36:39], v49
  ds_read_b128 v[40:43], v50
  ds_read_b128 v[44:47], v51
  s_waitcnt lgkmcnt(4)
  v_mov_b32 v29, v28
  v_mov_b64 v[30:31], v[28:29]
  s_waitcnt lgkmcnt(3)
  s_nop 0
  v_mfma_f32_16x16x32_bf16 v[0:3], v[70:73], v[32:35], v[28:31]
  v_mfma_f32_16x16x32_bf16 v[4:7], v[74:77], v[32:35], v[28:31]
  v_mfma_f32_16x16x32_bf16 v[8:11], v[78:81], v[32:35], v[28:31]
  v_mfma_f32_16x16x32_bf16 v[12:15], v[82:85], v[32:35], v[28:31]
  s_waitcnt lgkmcnt(2)
  v_mfma_f32_16x16x32_bf16 v[0:3], v[86:89], v[36:39], v[0:3]
  v_mfma_f32_16x16x32_bf16 v[4:7], v[90:93], v[36:39], v[4:7]
  v_mfma_f32_16x16x32_bf16 v[8:11], v[94:97], v[36:39], v[8:11]
  v_mfma_f32_16x16x32_bf16 v[12:15], v[98:101], v[36:39], v[12:15]
  s_waitcnt lgkmcnt(1)
  v_mfma_f32_16x16x32_bf16 v[0:3], v[102:105], v[40:43], v[0:3]
  v_mfma_f32_16x16x32_bf16 v[4:7], v[106:109], v[40:43], v[4:7]
  v_mfma_f32_16x16x32_bf16 v[8:11], v[110:113], v[40:43], v[8:11]
  v_mfma_f32_16x16x32_bf16 v[12:15], v[114:117], v[40:43], v[12:15]
  s_waitcnt lgkmcnt(0)
  v_mfma_f32_16x16x16_bf16 v[0:3], v[118:119], v[44:45], v[0:3]
  v_mfma_f32_16x16x16_bf16 v[4:7], v[120:121], v[44:45], v[4:7]
  v_mfma_f32_16x16x16_bf16 v[8:11], v[122:123], v[44:45], v[8:11]
  v_mfma_f32_16x16x16_bf16 v[12:15], v[124:125], v[44:45], v[12:15]
  s_nop 4
  v_cvt_pk_bf16_f32 v52, v0, v1
  v_cvt_pk_bf16_f32 v53, v2, v3
  v_cvt_pk_bf16_f32 v54, v4, v5
  v_cvt_pk_bf16_f32 v55, v6, v7
  ds_write2_b64 v21, v[52:53], v[54:55] offset0:0 offset1:4
  v_cvt_pk_bf16_f32 v56, v8, v9
  v_cvt_pk_bf16_f32 v57, v10, v11
  v_cvt_pk_bf16_f32 v58, v12, v13
  v_cvt_pk_bf16_f32 v59, v14, v15
  ds_write2_b64 v21, v[56:57], v[58:59] offset0:8 offset1:12
  ds_read_b128 v[32:35], v22
  ds_read_b128 v[36:39], v22 offset:1152
  s_waitcnt lgkmcnt(1)
  buffer_store_dwordx4 v[32:35], v24, s[40:43], 0 offen sc1
  s_waitcnt lgkmcnt(0)
  buffer_store_dwordx4 v[36:39], v25, s[40:43], 0 offen sc1
  s_waitcnt lgkmcnt(0)
  s_branch L_fend
L_fin6:
  v_mul_f32 v48, v0, v0
  v_mul_f32 v49, v1, v1
  v_add_f32 v44, v0, v2
  v_add_f32 v45, v1, v3
  v_fmac_f32 v48, v2, v2
  v_fmac_f32 v49, v3, v3
  v_add_f32 v44, v44, v4
  v_fmac_f32 v48, v4, v4
  v_add_f32 v45, v45, v5
  v_fmac_f32 v49, v5, v5
  v_add_f32 v44, v44, v6
  v_fmac_f32 v48, v6, v6
  v_add_f32 v45, v45, v7
  v_fmac_f32 v49, v7, v7
  v_add_f32 v44, v44, v8
  v_fmac_f32 v48, v8, v8
  v_add_f32 v45, v45, v9
  v_fmac_f32 v49, v9, v9
  v_add_f32 v44, v44, v10
  v_fmac_f32 v48, v10, v10
  v_add_f32 v45, v45, v11
  v_fmac_f32 v49, v11, v11
  v_add_f32 v44, v44, v12
  v_fmac_f32 v48, v12, v12
  v_add_f32 v45, v45, v13
  v_fmac_f32 v49, v13, v13
  v_add_f32 v44, v44, v14
  v_fmac_f32 v48, v14, v14
  v_add_f32 v45, v45, v15
  v_fmac_f32 v49, v15, v15
  v_add_f32 v44, v44, v45
  v_add_f32 v48, v48, v49
  v_mul_f32 v49, v63, v63
  v_mov_b32 v50, 0x3727c5ac
  v_permlane16_swap_b32 v44, v48
  v_add_f32 v44, v44, v48
  v_mov_b32 v48, v44
  v_lshlrev_b32 v69, 4, v68
  v_add_u32 v69, 143360, v69
  v_permlane32_swap_b32 v44, v48
  v_add_f32 v44, v44, v48
  v_mul_f32 v44, 0x3c800000, v44
  v_mov_b32 v48, v44
  ds_read_b32 v70, v69 offset:18432
  ds_read_b128 v[24:27], v69 offset:6144
  v_permlane16_swap_b32 v44, v48
  v_fma_f32 v48, -v44, v44, v48
  v_max_f32 v48, 0, v48
  v_fmac_f32 v50, v49, v48
  v_rsq_f32 v49, v50
  v_mul_f32 v47, v44, v63
  v_mul_f32 v46, v50, v49
  v_mul_f32 v48, v49, v63
  v_mul_f32 v49, v49, v47
  ds_read_b128 v[28:31], v69 offset:7168
  v_fma_f32 v0, v48, v0, -v49
  v_fma_f32 v1, v48, v1, -v49
  v_fma_f32 v2, v48, v2, -v49
  v_fma_f32 v3, v48, v3, -v49
  v_fma_f32 v4, v48, v4, -v49
  v_fma_f32 v5, v48, v5, -v49
  v_fma_f32 v6, v48, v6, -v49
  v_fma_f32 v7, v48, v7, -v49
  ds_write_b64 v65, v[46:47] offset:7992
  v_cvt_pk_bf16_f32 v16, v0, v1
  v_cvt_pk_bf16_f32 v17, v2, v3
  v_cvt_pk_bf16_f32 v18, v4, v5
  v_cvt_pk_bf16_f32 v19, v6, v7
  v_fma_f32 v8, v48, v8, -v49
  v_fma_f32 v9, v48, v9, -v49
  v_fma_f32 v10, v48, v10, -v49
  v_fma_f32 v11, v48, v11, -v49
  v_fma_f32 v12, v48, v12, -v49
  v_fma_f32 v13, v48, v13, -v49
  v_fma_f32 v14, v48, v14, -v49
  v_fma_f32 v15, v48, v15, -v49
  ds_write2_b64 v66, v[16:17], v[18:19] offset0:0 offset1:4
  v_cvt_pk_bf16_f32 v20, v8, v9
  v_cvt_pk_bf16_f32 v21, v10, v11
  v_cvt_pk_bf16_f32 v22, v12, v13
  v_cvt_pk_bf16_f32 v23, v14, v15
  ds_write2_b64 v66, v[20:21], v[22:23] offset0:8 offset1:12
  s_mov_b64 exec, s[78:79]
  ds_read_b128 v[72:75], v64 offset:0
  ds_read_b128 v[76:79], v64 offset:64
  s_mov_b64 exec, -1
  s_mov_b64 exec, s[78:79]
  ds_read_b128 v[80:83], v64 offset:288
  ds_read_b128 v[84:87], v64 offset:352
  s_mov_b64 exec, -1
  s_mov_b64 exec, s[78:79]
  ds_read_b128 v[88:91], v64 offset:576
  ds_read_b128 v[92:95], v64 offset:640
  s_mov_b64 exec, -1
  s_mov_b64 exec, s[78:79]
  ds_read_b128 v[96:99], v64 offset:864
  ds_read_b128 v[100:103], v64 offset:928
  s_mov_b64 exec, -1
  s_mov_b64 exec, s[78:79]
  ds_read_b128 v[104:107], v64 offset:1152
  ds_read_b128 v[108:111], v64 offset:1216
  s_mov_b64 exec, -1
  s_mov_b64 exec, s[78:79]
  ds_read_b128 v[112:115], v64 offset:1440
  ds_read_b128 v[116:119], v64 offset:1504
  s_mov_b64 exec, -1
  ds_read_b128 v[0:3], v69 offset:0
  ds_read_b128 v[4:7], v69 offset:1024
  ds_read_b128 v[8:11], v69 offset:2048
  ds_read_b128 v[12:15], v69 offset:3072
  s_waitcnt lgkmcnt(13)
  v_mfma_f32_16x16x32_bf16 v[32:35], v[24:27], v[80:83], 0
  ds_read_b128 v[16:19], v69 offset:4096
  ds_read_b128 v[20:23], v69 offset:5120
  s_waitcnt lgkmcnt(14)
  v_mfma_f32_16x16x32_bf16 v[32:35], v[28:31], v[84:87], v[32:35]
  v_mad_u32_u16 v70, v70, 4, s52 op_sel:[0,0,0,0]
  ds_read_b32 v71, v70 offset:7936
  v_lshl_add_u32 v68, v68, 3, s52
  s_nop 4
  v_cvt_pk_bf16_f32 v50, v32, v33
  v_cvt_pk_bf16_f32 v51, v34, v35
  v_mfma_f32_16x16x32_bf16 v[32:35], v[24:27], v[72:75], 0
  s_waitcnt lgkmcnt(6)
  v_mfma_f32_16x16x32_bf16 v[36:39], v[0:3], v[80:83], 0
  s_waitcnt lgkmcnt(4)
  v_mfma_f32_16x16x32_bf16 v[40:43], v[8:11], v[80:83], 0
  v_mfma_f32_16x16x32_bf16 v[36:39], v[4:7], v[84:87], v[36:39]
  s_waitcnt lgkmcnt(3)
  v_mfma_f32_16x16x32_bf16 v[40:43], v[12:15], v[84:87], v[40:43]
  s_waitcnt lgkmcnt(2)
  v_mfma_f32_16x16x32_bf16 v[64:67], v[16:19], v[80:83], 0
  s_waitcnt lgkmcnt(1)
  v_mfma_f32_16x16x32_bf16 v[64:67], v[20:23], v[84:87], v[64:67]
  v_mfma_f32_16x16x32_bf16 v[32:35], v[28:31], v[76:79], v[32:35]
  s_nop 0
  v_cvt_pk_bf16_f32 v44, v36, v37
  v_cvt_pk_bf16_f32 v45, v38, v39
  v_mfma_f32_16x16x32_bf16 v[36:39], v[0:3], v[72:75], 0
  v_cvt_pk_bf16_f32 v46, v40, v41
  v_cvt_pk_bf16_f32 v47, v42, v43
  v_mfma_f32_16x16x32_bf16 v[40:43], v[8:11], v[72:75], 0
  v_cvt_pk_bf16_f32 v48, v64, v65
  v_cvt_pk_bf16_f32 v49, v66, v67
  v_mfma_f32_16x16x32_bf16 v[36:39], v[4:7], v[76:79], v[36:39]
  v_mfma_f32_16x16x32_bf16 v[40:43], v[12:15], v[76:79], v[40:43]
  v_mfma_f32_16x16x32_bf16 v[64:67], v[16:19], v[72:75], 0
  v_mfma_f32_16x16x32_bf16 v[64:67], v[20:23], v[76:79], v[64:67]
  v_mfma_f32_16x16x32_bf16 v[56:59], v[80:83], v[44:47], 0
  v_mfma_f32_16x16x32_bf16 v[56:59], v[84:87], v[48:51], v[56:59]
  v_cvt_pk_bf16_f32 v50, v32, v33
  v_cvt_pk_bf16_f32 v51, v34, v35
  v_mfma_f32_16x16x32_bf16 v[32:35], v[24:27], v[96:99], 0
  v_cvt_pk_bf16_f32 v44, v36, v37
  v_cvt_pk_bf16_f32 v45, v38, v39
  v_mfma_f32_16x16x32_bf16 v[36:39], v[0:3], v[96:99], 0
  v_cvt_pk_bf16_f32 v46, v40, v41
  v_cvt_pk_bf16_f32 v47, v42, v43
  v_mfma_f32_16x16x32_bf16 v[40:43], v[8:11], v[96:99], 0
  v_cvt_pk_bf16_f32 v48, v64, v65
  v_cvt_pk_bf16_f32 v49, v66, v67
  v_mfma_f32_16x16x32_bf16 v[52:55], v[72:75], v[44:47], 0
  s_nop 0
  v_mfma_f32_16x16x32_bf16 v[52:55], v[76:79], v[48:51], v[52:55]
  v_mfma_f32_16x16x32_bf16 v[36:39], v[4:7], v[100:103], v[36:39]
  v_mfma_f32_16x16x32_bf16 v[40:43], v[12:15], v[100:103], v[40:43]
  v_mfma_f32_16x16x32_bf16 v[64:67], v[16:19], v[96:99], 0
  v_mfma_f32_16x16x32_bf16 v[32:35], v[28:31], v[100:103], v[32:35]
  v_mfma_f32_16x16x32_bf16 v[64:67], v[20:23], v[100:103], v[64:67]
  s_nop 2
  v_cndmask_b32_dpp v52, v56, v52, vcc row_ror:8 row_mask:0xf bank_mask:0xf
  v_cvt_pk_bf16_f32 v44, v36, v37
  v_cndmask_b32_dpp v53, v57, v53, vcc row_ror:8 row_mask:0xf bank_mask:0xf
  v_cvt_pk_bf16_f32 v45, v38, v39
  v_mfma_f32_16x16x32_bf16 v[36:39], v[0:3], v[88:91], 0
  v_cndmask_b32_dpp v54, v58, v54, vcc row_ror:8 row_mask:0xf bank_mask:0xf
  v_max3_f32 v60, v52, v53, v54
  v_mfma_f32_16x16x32_bf16 v[36:39], v[4:7], v[92:95], v[36:39]
  v_cndmask_b32_dpp v55, v59, v55, vcc row_ror:8 row_mask:0xf bank_mask:0xf
  v_max_f32 v60, v60, v55
  v_mov_b32 v61, v60
  v_cvt_pk_bf16_f32 v46, v40, v41
  v_cvt_pk_bf16_f32 v47, v42, v43
  v_mfma_f32_16x16x32_bf16 v[40:43], v[8:11], v[88:91], 0
  v_permlane16_swap_b32 v61, v60
  v_mfma_f32_16x16x32_bf16 v[40:43], v[12:15], v[92:95], v[40:43]
  v_max_f32 v60, v60, v61
  v_sub_f32 v52, v52, v60
  v_mfma_f32_16x16x32_bf16 v[56:59], v[96:99], v[44:47], 0
  v_sub_f32 v53, v53, v60
  v_sub_f32 v54, v54, v60
  v_sub_f32 v55, v55, v60
  v_exp_f32 v52, v52
  v_exp_f32 v53, v53
  v_exp_f32 v54, v54
  v_exp_f32 v55, v55
  v_cvt_pk_bf16_f32 v50, v32, v33
  v_cvt_pk_bf16_f32 v51, v34, v35
  v_mfma_f32_16x16x32_bf16 v[32:35], v[24:27], v[88:91], 0
  v_cvt_pk_bf16_f32 v48, v64, v65
  v_cvt_pk_bf16_f32 v49, v66, v67
  v_mfma_f32_16x16x32_bf16 v[64:67], v[16:19], v[88:91], 0
  v_add_f32 v60, v52, v53
  v_add_f32 v61, v54, v55
  v_mfma_f32_16x16x32_bf16 v[32:35], v[28:31], v[92:95], v[32:35]
  v_add_f32 v60, v60, v61
  v_mov_b32 v61, v60
  v_mfma_f32_16x16x32_bf16 v[64:67], v[20:23], v[92:95], v[64:67]
  v_cvt_pk_bf16_f32 v44, v36, v37
  v_permlane16_swap_b32 v61, v60
  v_mfma_f32_16x16x32_bf16 v[56:59], v[100:103], v[48:51], v[56:59]
  v_add_f32 v60, v60, v61
  s_waitcnt lgkmcnt(0)
  v_mul_f32 v60, v60, v71
  v_rcp_f32 v60, v60
  v_cvt_pk_bf16_f32 v45, v38, v39
  v_mfma_f32_16x16x32_bf16 v[36:39], v[0:3], v[112:115], 0
  v_cvt_pk_bf16_f32 v46, v40, v41
  v_cvt_pk_bf16_f32 v47, v42, v43
  v_mfma_f32_16x16x32_bf16 v[40:43], v[8:11], v[112:115], 0
  v_mul_f32 v52, v52, v60
  v_mul_f32 v53, v53, v60
  v_mfma_f32_16x16x32_bf16 v[36:39], v[4:7], v[116:119], v[36:39]
  v_mul_f32 v54, v54, v60
  v_mul_f32 v55, v55, v60
  v_mfma_f32_16x16x32_bf16 v[40:43], v[12:15], v[116:119], v[40:43]
  v_cvt_pk_bf16_f32 v60, v52, v53
  v_cvt_pk_bf16_f32 v61, v54, v55
  v_mfma_f32_16x16x32_bf16 v[52:55], v[88:91], v[44:47], 0
  v_cvt_pk_bf16_f32 v50, v32, v33
  v_cvt_pk_bf16_f32 v51, v34, v35
  v_mfma_f32_16x16x32_bf16 v[32:35], v[24:27], v[112:115], 0
  v_cvt_pk_bf16_f32 v48, v64, v65
  v_cvt_pk_bf16_f32 v49, v66, v67
  v_mfma_f32_16x16x32_bf16 v[64:67], v[16:19], v[112:115], 0
  ds_write_b64 v68, v[60:61] offset:4608
  ds_read_b32 v71, v70 offset:8192
  v_mfma_f32_16x16x32_bf16 v[52:55], v[92:95], v[48:51], v[52:55]
  v_cvt_pk_bf16_f32 v44, v36, v37
  v_cvt_pk_bf16_f32 v45, v38, v39
  v_mfma_f32_16x16x32_bf16 v[32:35], v[28:31], v[116:119], v[32:35]
  v_cvt_pk_bf16_f32 v46, v40, v41
  v_cvt_pk_bf16_f32 v47, v42, v43
  v_mfma_f32_16x16x32_bf16 v[64:67], v[20:23], v[116:119], v[64:67]
  v_mfma_f32_16x16x32_bf16 v[36:39], v[0:3], v[104:107], 0
  s_nop 0
  v_cndmask_b32_dpp v52, v56, v52, vcc row_ror:8 row_mask:0xf bank_mask:0xf
  v_mfma_f32_16x16x32_bf16 v[40:43], v[8:11], v[104:107], 0
  v_cndmask_b32_dpp v53, v57, v53, vcc row_ror:8 row_mask:0xf bank_mask:0xf
  v_cvt_pk_bf16_f32 v50, v32, v33
  v_mfma_f32_16x16x32_bf16 v[36:39], v[4:7], v[108:111], v[36:39]
  v_cndmask_b32_dpp v54, v58, v54, vcc row_ror:8 row_mask:0xf bank_mask:0xf
  v_max3_f32 v60, v52, v53, v54
  v_mfma_f32_16x16x32_bf16 v[40:43], v[12:15], v[108:111], v[40:43]
  v_cndmask_b32_dpp v55, v59, v55, vcc row_ror:8 row_mask:0xf bank_mask:0xf
  v_max_f32 v60, v60, v55
  v_mfma_f32_16x16x32_bf16 v[56:59], v[112:115], v[44:47], 0
  v_mov_b32 v61, v60
  v_cvt_pk_bf16_f32 v51, v34, v35
  v_mfma_f32_16x16x32_bf16 v[32:35], v[24:27], v[104:107], 0
  v_permlane16_swap_b32 v61, v60
  v_mfma_f32_16x16x32_bf16 v[32:35], v[28:31], v[108:111], v[32:35]
  v_max_f32 v60, v60, v61
  v_sub_f32 v52, v52, v60
  v_sub_f32 v53, v53, v60
  v_sub_f32 v54, v54, v60
  v_sub_f32 v55, v55, v60
  v_exp_f32 v52, v52
  v_exp_f32 v53, v53
  v_exp_f32 v54, v54
  v_exp_f32 v55, v55
  v_cvt_pk_bf16_f32 v48, v64, v65
  v_cvt_pk_bf16_f32 v49, v66, v67
  v_mfma_f32_16x16x32_bf16 v[64:67], v[16:19], v[104:107], 0
  v_add_f32 v60, v52, v53
  v_add_f32 v61, v54, v55
  v_mfma_f32_16x16x32_bf16 v[64:67], v[20:23], v[108:111], v[64:67]
  v_add_f32 v60, v60, v61
  v_mov_b32 v61, v60
  v_mfma_f32_16x16x32_bf16 v[56:59], v[116:119], v[48:51], v[56:59]
  v_cvt_pk_bf16_f32 v44, v36, v37
  v_permlane16_swap_b32 v61, v60
  v_add_f32 v60, v60, v61
  s_waitcnt lgkmcnt(0)
  v_mul_f32 v60, v60, v71
  v_rcp_f32 v60, v60
  v_cvt_pk_bf16_f32 v45, v38, v39
  v_cvt_pk_bf16_f32 v46, v40, v41
  v_cvt_pk_bf16_f32 v47, v42, v43
  v_mul_f32 v52, v52, v60
  v_mul_f32 v53, v53, v60
  v_mul_f32 v54, v54, v60
  v_mul_f32 v55, v55, v60
  v_cvt_pk_bf16_f32 v60, v52, v53
  v_cvt_pk_bf16_f32 v61, v54, v55
  v_mfma_f32_16x16x32_bf16 v[52:55], v[104:107], v[44:47], 0
  v_cvt_pk_bf16_f32 v50, v32, v33
  v_cvt_pk_bf16_f32 v51, v34, v35
  v_cvt_pk_bf16_f32 v48, v64, v65
  v_cvt_pk_bf16_f32 v49, v66, v67
  ds_write_b64 v68, v[60:61] offset:5376
  ds_read_b32 v71, v70 offset:8448
  v_mfma_f32_16x16x32_bf16 v[52:55], v[108:111], v[48:51], v[52:55]
  ds_read_b128 v[24:27], v69 offset:14336
  ds_read_b128 v[28:31], v69 offset:15360
  ds_read_b128 v[0:3], v69 offset:8192
  ds_read_b128 v[4:7], v69 offset:9216
  ds_read_b128 v[8:11], v69 offset:10240
  ds_read_b128 v[12:15], v69 offset:11264
  ds_read_b128 v[16:19], v69 offset:12288
  ds_read_b128 v[20:23], v69 offset:13312
  v_cndmask_b32_dpp v52, v56, v52, vcc row_ror:8 row_mask:0xf bank_mask:0xf
  v_cndmask_b32_dpp v53, v57, v53, vcc row_ror:8 row_mask:0xf bank_mask:0xf
  v_cndmask_b32_dpp v54, v58, v54, vcc row_ror:8 row_mask:0xf bank_mask:0xf
  v_max3_f32 v60, v52, v53, v54
  v_cndmask_b32_dpp v55, v59, v55, vcc row_ror:8 row_mask:0xf bank_mask:0xf
  ds_read_b128 v[56:59], v69 offset:18432
  v_max_f32 v60, v60, v55
  v_mov_b32 v61, v60
  s_waitcnt lgkmcnt(8)
  v_mfma_f32_16x16x32_bf16 v[64:67], v[72:75], v[24:27], 0
  ds_read_b128 v[44:47], v69 offset:16384
  v_permlane16_swap_b32 v61, v60
  s_waitcnt lgkmcnt(7)
  v_mfma_f32_16x16x32_bf16 v[32:35], v[72:75], v[0:3], 0
  v_max_f32 v60, v60, v61
  v_sub_f32 v52, v52, v60
  s_waitcnt lgkmcnt(6)
  v_mfma_f32_16x16x32_bf16 v[32:35], v[76:79], v[4:7], v[32:35]
  v_sub_f32 v53, v53, v60
  v_sub_f32 v54, v54, v60
  s_waitcnt lgkmcnt(5)
  v_mfma_f32_16x16x32_bf16 v[36:39], v[72:75], v[8:11], 0
  v_sub_f32 v55, v55, v60
  v_exp_f32 v52, v52
  s_waitcnt lgkmcnt(4)
  v_mfma_f32_16x16x32_bf16 v[36:39], v[76:79], v[12:15], v[36:39]
  v_exp_f32 v53, v53
  s_waitcnt lgkmcnt(3)
  v_mfma_f32_16x16x32_bf16 v[40:43], v[72:75], v[16:19], 0
  v_exp_f32 v54, v54
  s_waitcnt lgkmcnt(2)
  v_mfma_f32_16x16x32_bf16 v[40:43], v[76:79], v[20:23], v[40:43]
  v_exp_f32 v55, v55
  v_mfma_f32_16x16x32_bf16 v[64:67], v[76:79], v[28:31], v[64:67]
  v_add_f32 v60, v52, v53
  v_add_f32 v61, v54, v55
  v_add_f32 v60, v60, v61
  v_mov_b32 v61, v60
  ds_read_b128 v[48:51], v69 offset:17408
  s_waitcnt lgkmcnt(2)
  v_mad_u32_u16 v63, v58, 4, s52 op_sel:[0,0,0,0]
  v_permlane16_swap_b32 v61, v60
  v_add_f32 v60, v60, v61
  v_mul_f32 v60, v60, v71
  v_rcp_f32 v60, v60
  v_mad_u32_u16 v62, v57, 4, s52 op_sel:[1,0,0,0]
  v_mul_f32 v52, v52, v60
  v_mul_f32 v53, v53, v60
  v_mul_f32 v54, v54, v60
  v_mul_f32 v55, v55, v60
  v_cvt_pk_bf16_f32 v60, v52, v53
  v_cvt_pk_bf16_f32 v61, v54, v55
  ds_write_b64 v68, v[60:61] offset:6144
  ds_read_b64 v[70:71], v63
  v_cndmask_b32 v54, 0, v59, s[64:65]
  v_cndmask_b32 v55, v59, 0, s[64:65]
  v_cvt_pk_bf16_f32 v52, v32, v33
  v_cvt_pk_bf16_f32 v53, v34, v35
  v_mad_u32_u16 v60, v56, 4, s52 op_sel:[1,0,0,0]
  v_mad_u32_u16 v61, v57, 4, s52 op_sel:[0,0,0,0]
  v_mad_u32_u16 v68, v58, 4, s52 op_sel:[1,0,0,0]
  v_mov_b64 v[58:59], v[54:55]
  v_cvt_pk_bf16_f32 v56, v36, v37
  v_cvt_pk_bf16_f32 v57, v38, v39
  s_waitcnt lgkmcnt(0)
  v_mfma_f32_16x16x32_bf16 v[32:35], v[52:55], v[70:73], 0
  v_mov_b64 v[72:73], v[70:71]
  v_cvt_pk_bf16_f32 v52, v40, v41
  v_cvt_pk_bf16_f32 v53, v42, v43
  v_mfma_f32_16x16x32_bf16 v[36:39], v[56:59], v[72:75], 0
  v_mov_b64 v[74:75], v[72:73]
  v_cvt_pk_bf16_f32 v56, v64, v65
  v_cvt_pk_bf16_f32 v57, v66, v67
  v_mfma_f32_16x16x32_bf16 v[40:43], v[52:55], v[74:77], 0
  v_mov_b64 v[76:77], v[74:75]
  v_cvt_pk_bf16_f32 v70, v32, v33
  v_cvt_pk_bf16_f32 v71, v34, v35
  v_mfma_f32_16x16x32_bf16 v[64:67], v[56:59], v[76:79], 0
  ds_read_b64 v[78:79], v68 offset:0
  v_cvt_pk_bf16_f32 v72, v36, v37
  v_mfma_f32_16x16x32_bf16 v[32:35], v[80:83], v[0:3], 0
  v_cvt_pk_bf16_f32 v73, v38, v39
  v_cvt_pk_bf16_f32 v74, v40, v41
  v_mfma_f32_16x16x32_bf16 v[32:35], v[84:87], v[4:7], v[32:35]
  v_cvt_pk_bf16_f32 v75, v42, v43
  ds_write_b128 v60, v[70:73] offset:0
  v_mfma_f32_16x16x32_bf16 v[40:43], v[70:73], v[70:73], 0
  v_cvt_pk_bf16_f32 v76, v64, v65
  v_cvt_pk_bf16_f32 v77, v66, v67
  v_mfma_f32_16x16x32_bf16 v[64:67], v[44:47], v[70:73], 0
  ds_write_b128 v60, v[74:77] offset:1024
  v_mfma_f32_16x16x32_bf16 v[40:43], v[74:77], v[74:77], v[40:43]
  v_cvt_pk_bf16_f32 v52, v32, v33
  v_cvt_pk_bf16_f32 v53, v34, v35
  v_mfma_f32_16x16x32_bf16 v[64:67], v[48:51], v[74:77], v[64:67]
  v_mfma_f32_16x16x32_bf16 v[36:39], v[80:83], v[8:11], 0
  v_mfma_f32_16x16x32_bf16 v[36:39], v[84:87], v[12:15], v[36:39]
  s_waitcnt lgkmcnt(2)
  v_mfma_f32_16x16x32_bf16 v[32:35], v[52:55], v[78:81], 0
  s_nop 3
  v_cndmask_b32 v66, v42, v40, s[64:65]
  v_cndmask_b32 v67, v43, v41, s[64:65]
  v_mfma_f32_16x16x32_bf16 v[40:43], v[80:83], v[16:19], 0
  ds_write_b128 v62, v[64:67] offset:0
  v_cvt_pk_bf16_f32 v56, v36, v37
  v_mfma_f32_16x16x32_bf16 v[40:43], v[84:87], v[20:23], v[40:43]
  v_cvt_pk_bf16_f32 v57, v38, v39
  v_mfma_f32_16x16x32_bf16 v[64:67], v[80:83], v[24:27], 0
  v_mov_b64 v[80:81], v[78:79]
  v_cvt_pk_bf16_f32 v78, v32, v33
  v_mfma_f32_16x16x32_bf16 v[64:67], v[84:87], v[28:31], v[64:67]
  v_cvt_pk_bf16_f32 v79, v34, v35
  v_mfma_f32_16x16x32_bf16 v[36:39], v[56:59], v[80:83], 0
  v_mov_b64 v[82:83], v[80:81]
  v_cvt_pk_bf16_f32 v52, v40, v41
  v_mfma_f32_16x16x32_bf16 v[32:35], v[88:91], v[0:3], 0
  v_cvt_pk_bf16_f32 v53, v42, v43
  v_mfma_f32_16x16x32_bf16 v[32:35], v[92:95], v[4:7], v[32:35]
  s_nop 0
  v_cvt_pk_bf16_f32 v56, v64, v65
  v_mfma_f32_16x16x32_bf16 v[40:43], v[52:55], v[82:85], 0
  v_mov_b64 v[84:85], v[82:83]
  v_cvt_pk_bf16_f32 v57, v66, v67
  v_cvt_pk_bf16_f32 v80, v36, v37
  v_cvt_pk_bf16_f32 v81, v38, v39
  v_mfma_f32_16x16x32_bf16 v[64:67], v[56:59], v[84:87], 0
  ds_read_b64 v[86:87], v63 offset:768
  ds_write_b128 v60, v[78:81] offset:2048
  v_mfma_f32_16x16x32_bf16 v[36:39], v[88:91], v[8:11], 0
  v_cvt_pk_bf16_f32 v82, v40, v41
  v_cvt_pk_bf16_f32 v83, v42, v43
  v_mfma_f32_16x16x32_bf16 v[40:43], v[78:81], v[78:81], 0
  v_cvt_pk_bf16_f32 v52, v32, v33
  v_cvt_pk_bf16_f32 v53, v34, v35
  v_mfma_f32_16x16x32_bf16 v[36:39], v[92:95], v[12:15], v[36:39]
  v_cvt_pk_bf16_f32 v84, v64, v65
  v_cvt_pk_bf16_f32 v85, v66, v67
  v_mfma_f32_16x16x32_bf16 v[64:67], v[44:47], v[78:81], 0
  ds_write_b128 v60, v[82:85] offset:3072
  ds_read_b64_tr_b16 v[70:71], v61 offset:0
  v_mfma_f32_16x16x32_bf16 v[40:43], v[82:85], v[82:85], v[40:43]
  ds_read_b64_tr_b16 v[74:75], v61 offset:512
  ds_read_b64_tr_b16 v[78:79], v61 offset:1024
  v_mfma_f32_16x16x32_bf16 v[64:67], v[48:51], v[82:85], v[64:67]
  ds_read_b64_tr_b16 v[82:83], v61 offset:1536
  ds_read_b64_tr_b16 v[72:73], v61 offset:2048
  s_waitcnt lgkmcnt(7)
  v_mfma_f32_16x16x32_bf16 v[32:35], v[52:55], v[86:89], 0
  ds_read_b64_tr_b16 v[76:77], v61 offset:2560
  ds_read_b64_tr_b16 v[80:81], v61 offset:3072
  ds_read_b64_tr_b16 v[84:85], v61 offset:3584
  v_cvt_pk_bf16_f32 v56, v36, v37
  v_cvt_pk_bf16_f32 v57, v38, v39
  v_cndmask_b32 v66, v42, v40, s[64:65]
  v_cndmask_b32 v67, v43, v41, s[64:65]
  v_mfma_f32_16x16x32_bf16 v[40:43], v[88:91], v[16:19], 0
  ds_write_b128 v62, v[64:67] offset:384
  v_mfma_f32_16x16x32_bf16 v[40:43], v[92:95], v[20:23], v[40:43]
  v_mfma_f32_16x16x32_bf16 v[64:67], v[88:91], v[24:27], 0
  v_mov_b64 v[88:89], v[86:87]
  v_cvt_pk_bf16_f32 v86, v32, v33
  v_mfma_f32_16x16x32_bf16 v[64:67], v[92:95], v[28:31], v[64:67]
  v_cvt_pk_bf16_f32 v87, v34, v35
  v_mfma_f32_16x16x32_bf16 v[36:39], v[56:59], v[88:91], 0
  v_mov_b64 v[90:91], v[88:89]
  v_mfma_f32_16x16x32_bf16 v[32:35], v[96:99], v[0:3], 0
  v_cvt_pk_bf16_f32 v52, v40, v41
  v_cvt_pk_bf16_f32 v53, v42, v43
  v_mfma_f32_16x16x32_bf16 v[32:35], v[100:103], v[4:7], v[32:35]
  s_nop 0
  v_cvt_pk_bf16_f32 v56, v64, v65
  v_mfma_f32_16x16x32_bf16 v[40:43], v[52:55], v[90:93], 0
  v_mov_b64 v[92:93], v[90:91]
  v_cvt_pk_bf16_f32 v57, v66, v67
  v_cvt_pk_bf16_f32 v88, v36, v37
  v_cvt_pk_bf16_f32 v89, v38, v39
  v_mfma_f32_16x16x32_bf16 v[64:67], v[56:59], v[92:95], 0
  ds_read_b64 v[94:95], v68 offset:768
  ds_write_b128 v60, v[86:89] offset:0
  v_mfma_f32_16x16x32_bf16 v[36:39], v[96:99], v[8:11], 0
  v_cvt_pk_bf16_f32 v90, v40, v41
  v_cvt_pk_bf16_f32 v91, v42, v43
  v_mfma_f32_16x16x32_bf16 v[40:43], v[86:89], v[86:89], 0
  v_cvt_pk_bf16_f32 v52, v32, v33
  v_cvt_pk_bf16_f32 v53, v34, v35
  v_mfma_f32_16x16x32_bf16 v[36:39], v[100:103], v[12:15], v[36:39]
  v_cvt_pk_bf16_f32 v92, v64, v65
  v_cvt_pk_bf16_f32 v93, v66, v67
  v_mfma_f32_16x16x32_bf16 v[64:67], v[44:47], v[86:89], 0
  ds_write_b128 v60, v[90:93] offset:1024
  v_mfma_f32_16x16x32_bf16 v[40:43], v[90:93], v[90:93], v[40:43]
  v_mfma_f32_16x16x32_bf16 v[64:67], v[48:51], v[90:93], v[64:67]
  s_waitcnt lgkmcnt(2)
  v_mfma_f32_16x16x32_bf16 v[32:35], v[52:55], v[94:97], 0
  v_cvt_pk_bf16_f32 v56, v36, v37
  v_cvt_pk_bf16_f32 v57, v38, v39
  s_nop 3
  v_cndmask_b32 v66, v42, v40, s[64:65]
  v_cndmask_b32 v67, v43, v41, s[64:65]
  v_mfma_f32_16x16x32_bf16 v[40:43], v[96:99], v[16:19], 0
  ds_write_b128 v62, v[64:67] offset:768
  v_mfma_f32_16x16x32_bf16 v[40:43], v[100:103], v[20:23], v[40:43]
  v_mfma_f32_16x16x32_bf16 v[64:67], v[96:99], v[24:27], 0
  v_mov_b64 v[96:97], v[94:95]
  v_cvt_pk_bf16_f32 v94, v32, v33
  v_mfma_f32_16x16x32_bf16 v[64:67], v[100:103], v[28:31], v[64:67]
  v_cvt_pk_bf16_f32 v95, v34, v35
  v_mfma_f32_16x16x32_bf16 v[36:39], v[56:59], v[96:99], 0
  v_mov_b64 v[98:99], v[96:97]
  v_mfma_f32_16x16x32_bf16 v[32:35], v[104:107], v[0:3], 0
  v_cvt_pk_bf16_f32 v52, v40, v41
  v_cvt_pk_bf16_f32 v53, v42, v43
  v_mfma_f32_16x16x32_bf16 v[32:35], v[108:111], v[4:7], v[32:35]
  s_nop 0
  v_cvt_pk_bf16_f32 v56, v64, v65
  v_mfma_f32_16x16x32_bf16 v[40:43], v[52:55], v[98:101], 0
  v_mov_b64 v[100:101], v[98:99]
  v_cvt_pk_bf16_f32 v57, v66, v67
  v_cvt_pk_bf16_f32 v96, v36, v37
  v_cvt_pk_bf16_f32 v97, v38, v39
  v_mfma_f32_16x16x32_bf16 v[64:67], v[56:59], v[100:103], 0
  ds_read_b64 v[102:103], v63 offset:1536
  ds_write_b128 v60, v[94:97] offset:2048
  v_mfma_f32_16x16x32_bf16 v[36:39], v[104:107], v[8:11], 0
  v_cvt_pk_bf16_f32 v98, v40, v41
  v_cvt_pk_bf16_f32 v99, v42, v43
  v_mfma_f32_16x16x32_bf16 v[40:43], v[94:97], v[94:97], 0
  v_cvt_pk_bf16_f32 v52, v32, v33
  v_cvt_pk_bf16_f32 v53, v34, v35
  v_mfma_f32_16x16x32_bf16 v[36:39], v[108:111], v[12:15], v[36:39]
  v_cvt_pk_bf16_f32 v100, v64, v65
  v_cvt_pk_bf16_f32 v101, v66, v67
  v_mfma_f32_16x16x32_bf16 v[64:67], v[44:47], v[94:97], 0
  ds_write_b128 v60, v[98:101] offset:3072
  ds_read_b64_tr_b16 v[86:87], v61 offset:0
  v_mfma_f32_16x16x32_bf16 v[40:43], v[98:101], v[98:101], v[40:43]
  ds_read_b64_tr_b16 v[90:91], v61 offset:512
  ds_read_b64_tr_b16 v[94:95], v61 offset:1024
  v_mfma_f32_16x16x32_bf16 v[64:67], v[48:51], v[98:101], v[64:67]
  ds_read_b64_tr_b16 v[98:99], v61 offset:1536
  ds_read_b64_tr_b16 v[88:89], v61 offset:2048
  s_waitcnt lgkmcnt(7)
  v_mfma_f32_16x16x32_bf16 v[32:35], v[52:55], v[102:105], 0
  ds_read_b64_tr_b16 v[92:93], v61 offset:2560
  ds_read_b64_tr_b16 v[96:97], v61 offset:3072
  ds_read_b64_tr_b16 v[100:101], v61 offset:3584
  v_cvt_pk_bf16_f32 v56, v36, v37
  v_cvt_pk_bf16_f32 v57, v38, v39
  v_cndmask_b32 v66, v42, v40, s[64:65]
  v_cndmask_b32 v67, v43, v41, s[64:65]
  v_mfma_f32_16x16x32_bf16 v[40:43], v[104:107], v[16:19], 0
  ds_write_b128 v62, v[64:67] offset:1152
  v_mfma_f32_16x16x32_bf16 v[40:43], v[108:111], v[20:23], v[40:43]
  v_mfma_f32_16x16x32_bf16 v[64:67], v[104:107], v[24:27], 0
  v_mov_b64 v[104:105], v[102:103]
  v_cvt_pk_bf16_f32 v102, v32, v33
  v_mfma_f32_16x16x32_bf16 v[64:67], v[108:111], v[28:31], v[64:67]
  v_cvt_pk_bf16_f32 v103, v34, v35
  v_mfma_f32_16x16x32_bf16 v[36:39], v[56:59], v[104:107], 0
  v_mov_b64 v[106:107], v[104:105]
  v_mfma_f32_16x16x32_bf16 v[32:35], v[112:115], v[0:3], 0
  v_cvt_pk_bf16_f32 v52, v40, v41
  v_cvt_pk_bf16_f32 v53, v42, v43
  v_mfma_f32_16x16x32_bf16 v[32:35], v[116:119], v[4:7], v[32:35]
  s_nop 0
  v_cvt_pk_bf16_f32 v56, v64, v65
  v_mfma_f32_16x16x32_bf16 v[40:43], v[52:55], v[106:109], 0
  v_mov_b64 v[108:109], v[106:107]
  v_cvt_pk_bf16_f32 v57, v66, v67
  v_cvt_pk_bf16_f32 v104, v36, v37
  v_cvt_pk_bf16_f32 v105, v38, v39
  v_mfma_f32_16x16x32_bf16 v[64:67], v[56:59], v[108:111], 0
  ds_read_b64 v[110:111], v68 offset:1536
  ds_write_b128 v60, v[102:105] offset:0
  v_mfma_f32_16x16x32_bf16 v[36:39], v[112:115], v[8:11], 0
  v_cvt_pk_bf16_f32 v106, v40, v41
  v_cvt_pk_bf16_f32 v107, v42, v43
  v_mfma_f32_16x16x32_bf16 v[40:43], v[102:105], v[102:105], 0
  v_cvt_pk_bf16_f32 v52, v32, v33
  v_cvt_pk_bf16_f32 v53, v34, v35
  v_mfma_f32_16x16x32_bf16 v[36:39], v[116:119], v[12:15], v[36:39]
  v_cvt_pk_bf16_f32 v108, v64, v65
  v_cvt_pk_bf16_f32 v109, v66, v67
  v_mfma_f32_16x16x32_bf16 v[64:67], v[44:47], v[102:105], 0
  ds_write_b128 v60, v[106:109] offset:1024
  v_mfma_f32_16x16x32_bf16 v[40:43], v[106:109], v[106:109], v[40:43]
  v_mfma_f32_16x16x32_bf16 v[64:67], v[48:51], v[106:109], v[64:67]
  s_waitcnt lgkmcnt(2)
  v_mfma_f32_16x16x32_bf16 v[32:35], v[52:55], v[110:113], 0
  v_cvt_pk_bf16_f32 v56, v36, v37
  v_cvt_pk_bf16_f32 v57, v38, v39
  s_nop 3
  v_cndmask_b32 v66, v42, v40, s[64:65]
  v_cndmask_b32 v67, v43, v41, s[64:65]
  v_mfma_f32_16x16x32_bf16 v[40:43], v[112:115], v[16:19], 0
  ds_write_b128 v62, v[64:67] offset:1536
  v_mfma_f32_16x16x32_bf16 v[40:43], v[116:119], v[20:23], v[40:43]
  v_lshrrev_b32 v23, 1, v69
  v_add_u32 v23, s56, v23
  v_mfma_f32_16x16x32_bf16 v[64:67], v[112:115], v[24:27], 0
  v_mov_b64 v[112:113], v[110:111]
  v_cvt_pk_bf16_f32 v110, v32, v33
  v_mfma_f32_16x16x32_bf16 v[64:67], v[116:119], v[28:31], v[64:67]
  v_cvt_pk_bf16_f32 v111, v34, v35
  v_mov_b32 v26, 2147483648
  v_mfma_f32_16x16x32_bf16 v[36:39], v[56:59], v[112:115], 0
  v_mov_b64 v[114:115], v[112:113]
  v_cvt_pk_bf16_f32 v52, v40, v41
  v_cvt_pk_bf16_f32 v53, v42, v43
  s_nop 1
  v_mfma_f32_16x16x32_bf16 v[40:43], v[52:55], v[114:117], 0
  v_mov_b64 v[116:117], v[114:115]
  v_cvt_pk_bf16_f32 v56, v64, v65
  v_cvt_pk_bf16_f32 v57, v66, v67
  v_cvt_pk_bf16_f32 v112, v36, v37
  v_cvt_pk_bf16_f32 v113, v38, v39
  v_mfma_f32_16x16x32_bf16 v[64:67], v[56:59], v[116:119], 0
  ds_write_b128 v60, v[110:113] offset:2048
  s_nop 0
  v_cvt_pk_bf16_f32 v114, v40, v41
  v_cvt_pk_bf16_f32 v115, v42, v43
  v_mfma_f32_16x16x32_bf16 v[40:43], v[110:113], v[110:113], 0
  s_nop 2
  v_cvt_pk_bf16_f32 v116, v64, v65
  v_cvt_pk_bf16_f32 v117, v66, v67
  v_mfma_f32_16x16x32_bf16 v[64:67], v[44:47], v[110:113], 0
  ds_write_b128 v60, v[114:117] offset:3072
  ds_read_b64_tr_b16 v[102:103], v61 offset:0
  v_mfma_f32_16x16x32_bf16 v[40:43], v[114:117], v[114:117], v[40:43]
  ds_read_b64_tr_b16 v[106:107], v61 offset:512
  ds_read_b64_tr_b16 v[110:111], v61 offset:1024
  v_mfma_f32_16x16x32_bf16 v[64:67], v[48:51], v[114:117], v[64:67]
  ds_read_b64_tr_b16 v[114:115], v61 offset:1536
  ds_read_b64_tr_b16 v[104:105], v61 offset:2048
  ds_read_b64_tr_b16 v[108:109], v61 offset:2560
  ds_read_b64_tr_b16 v[112:113], v61 offset:3072
  ds_read_b64_tr_b16 v[116:117], v61 offset:3584
  v_mov_b64 v[44:45], 0
  s_nop 1
  v_cndmask_b32 v66, v42, v40, s[64:65]
  v_cndmask_b32 v67, v43, v41, s[64:65]
  ds_write_b128 v62, v[64:67] offset:1920
  ds_read_b128 v[28:31], v69 offset:19456
  ds_write_b64 v23, v[44:45] offset:16
  s_waitcnt lgkmcnt(1)
  v_mad_u32_u16 v17, v28, 4, s52 op_sel:[1,0,0,0]
  v_mad_u32_u16 v16, v28, 4, s52 op_sel:[0,0,0,0]
  ds_read_b32 v0, v17 offset:0
  ds_read_b64 v[2:3], v16 offset:0
  ds_read_b64 v[4:5], v23 offset:7936
  ds_read_b32 v8, v17 offset:1536
  ds_read_b64 v[10:11], v16 offset:1536
  ds_read_b64 v[12:13], v23 offset:8448
  v_mad_u32_u16 v18, v29, 2, s52 op_sel:[0,0,0,0]
  v_mad_u32_u16 v20, v30, 4, s52 op_sel:[0,0,0,0]
  v_mad_u32_u16 v19, v29, 4, s52 op_sel:[1,0,0,0]
  v_mad_u32_u16 v21, v30, 4, s52 op_sel:[1,0,0,0]
  v_cndmask_b32 v48, v26, v19, s[14:15]
  v_cndmask_b32 v49, v26, v19, s[16:17]
  v_cndmask_b32 v50, v26, v19, s[18:19]
  v_mad_u32_u16 v22, v31, 4, s52 op_sel:[0,0,0,0]
  v_mad_u32_u16 v24, v31, 16, s59 op_sel:[1,0,0,0]
  v_mad_u32_u16 v25, v31, 16, s58 op_sel:[1,0,0,0]
  s_nop 1
  v_mov_b32_dpp v25, v26 quad_perm:[0,1,2,3] row_mask:12 bank_mask:0xf
  s_waitcnt lgkmcnt(5)
  v_mul_f32 v0, 0x3c800000, v0
  s_waitcnt lgkmcnt(4)
  v_fma_f32 v0, -v2, v2, v0
  v_max_f32 v0, 0, v0
  s_waitcnt lgkmcnt(3)
  v_mul_f32 v1, v4, v4
  s_waitcnt lgkmcnt(2)
  v_mul_f32 v8, 0x3c800000, v8
  v_fma_f32 v0, v1, v0, s13
  s_waitcnt lgkmcnt(1)
  v_fma_f32 v8, -v10, v10, v8
  v_rsq_f32 v0, v0
  v_fma_f32 v3, -v2, s12, v3
  v_mul_f32 v1, 0x3fb8aa3b, v4
  v_max_f32 v8, 0, v8
  s_waitcnt lgkmcnt(0)
  v_mul_f32 v9, v12, v12
  v_mul_f32 v3, v3, v1
  v_fma_f32 v8, v9, v8, s13
  v_mul_f32 v3, v3, v0
  v_rsq_f32 v8, v8
  v_fma_f32 v11, -v10, s12, v11
  v_mul_f32 v9, 0x3fb8aa3b, v12
  v_mul_f32 v11, v11, v9
  v_mul_f32 v11, v11, v8
  v_max_f32_dpp v1, v3, v3 quad_perm:[1,0,3,2] row_mask:0xf bank_mask:0xf
  s_nop 0
  v_max_f32_dpp v9, v11, v11 quad_perm:[1,0,3,2] row_mask:0xf bank_mask:0xf
  v_max_f32_dpp v1, v1, v1 quad_perm:[2,3,0,1] row_mask:0xf bank_mask:0xf
  s_nop 0
  v_max_f32_dpp v9, v9, v9 quad_perm:[2,3,0,1] row_mask:0xf bank_mask:0xf
  v_max_f32_dpp v1, v1, v1 row_half_mirror row_mask:0xf bank_mask:0xf
  v_sub_f32 v3, v3, v1
  v_exp_f32 v3, v3
  v_max_f32_dpp v9, v9, v9 row_half_mirror row_mask:0xf bank_mask:0xf
  v_sub_f32 v11, v11, v9
  v_exp_f32 v11, v11
  v_add_f32_dpp v1, v3, v3 quad_perm:[1,0,3,2] row_mask:0xf bank_mask:0xf
  v_mul_f32 v5, v5, v3
  v_add_f32_dpp v9, v11, v11 quad_perm:[1,0,3,2] row_mask:0xf bank_mask:0xf
  v_add_f32_dpp v1, v1, v1 quad_perm:[2,3,0,1] row_mask:0xf bank_mask:0xf
  v_mul_f32 v13, v13, v11
  v_add_f32_dpp v5, v5, v5 quad_perm:[1,0,3,2] row_mask:0xf bank_mask:0xf
  v_add_f32_dpp v9, v9, v9 quad_perm:[2,3,0,1] row_mask:0xf bank_mask:0xf
  v_add_f32_dpp v1, v1, v1 row_half_mirror row_mask:0xf bank_mask:0xf
  v_add_f32_dpp v13, v13, v13 quad_perm:[1,0,3,2] row_mask:0xf bank_mask:0xf
  v_add_f32_dpp v5, v5, v5 quad_perm:[2,3,0,1] row_mask:0xf bank_mask:0xf
  v_rcp_f32 v1, v1
  v_mul_f32 v3, v3, v4
  v_add_f32_dpp v9, v9, v9 row_half_mirror row_mask:0xf bank_mask:0xf
  v_mul_f32 v3, v3, v1
  v_add_f32_dpp v13, v13, v13 quad_perm:[2,3,0,1] row_mask:0xf bank_mask:0xf
  v_rcp_f32 v9, v9
  v_add_f32_dpp v5, v5, v5 row_half_mirror row_mask:0xf bank_mask:0xf
  v_cvt_pk_bf16_f32 v3, v3, v3
  v_mul_f32 v11, v11, v12
  v_mul_f32 v5, v5, v1
  v_mul_f32 v11, v11, v9
  ds_write_b16 v18, v3 offset:16
  v_add_f32_dpp v13, v13, v13 row_half_mirror row_mask:0xf bank_mask:0xf
  v_cvt_pk_bf16_f32 v11, v11, v11
  ds_write_b32 v23, v5 offset:7936
  v_mul_f32 v13, v13, v9
  ds_write_b16 v18, v11 offset:272
  ds_write_b32 v23, v13 offset:8448
  ds_read_b32 v28, v20 offset:7936
  ds_read_b128 v[32:35], v48
  ds_read_b128 v[36:39], v49
  ds_read_b128 v[40:43], v50
  s_waitcnt lgkmcnt(3)
  v_mov_b32 v29, v28
  v_mov_b64 v[30:31], v[28:29]
  s_waitcnt lgkmcnt(2)
  s_nop 0
  v_mfma_f32_16x16x32_bf16 v[0:3], v[70:73], v[32:35], v[28:31]
  v_mfma_f32_16x16x32_bf16 v[4:7], v[74:77], v[32:35], v[28:31]
  v_mfma_f32_16x16x32_bf16 v[8:11], v[78:81], v[32:35], v[28:31]
  v_mfma_f32_16x16x32_bf16 v[12:15], v[82:85], v[32:35], v[28:31]
  s_waitcnt lgkmcnt(1)
  v_mfma_f32_16x16x32_bf16 v[0:3], v[86:89], v[36:39], v[0:3]
  v_mfma_f32_16x16x32_bf16 v[4:7], v[90:93], v[36:39], v[4:7]
  v_mfma_f32_16x16x32_bf16 v[8:11], v[94:97], v[36:39], v[8:11]
  v_mfma_f32_16x16x32_bf16 v[12:15], v[98:101], v[36:39], v[12:15]
  s_waitcnt lgkmcnt(0)
  v_mfma_f32_16x16x32_bf16 v[0:3], v[102:105], v[40:43], v[0:3]
  v_mfma_f32_16x16x32_bf16 v[4:7], v[106:109], v[40:43], v[4:7]
  v_mfma_f32_16x16x32_bf16 v[8:11], v[110:113], v[40:43], v[8:11]
  v_mfma_f32_16x16x32_bf16 v[12:15], v[114:117], v[40:43], v[12:15]
  s_nop 4
  v_cvt_pk_bf16_f32 v52, v0, v1
  v_cvt_pk_bf16_f32 v53, v2, v3
  v_cvt_pk_bf16_f32 v54, v4, v5
  v_cvt_pk_bf16_f32 v55, v6, v7
  ds_write2_b64 v21, v[52:53], v[54:55] offset0:0 offset1:4
  v_cvt_pk_bf16_f32 v56, v8, v9
  v_cvt_pk_bf16_f32 v57, v10, v11
  v_cvt_pk_bf16_f32 v58, v12, v13
  v_cvt_pk_bf16_f32 v59, v14, v15
  ds_write2_b64 v21, v[56:57], v[58:59] offset0:8 offset1:12
  ds_read_b128 v[32:35], v22
  ds_read_b128 v[36:39], v22 offset:1152
  s_waitcnt lgkmcnt(1)
  buffer_store_dwordx4 v[32:35], v24, s[40:43], 0 offen sc1
  s_waitcnt lgkmcnt(0)
  buffer_store_dwordx4 v[36:39], v25, s[40:43], 0 offen sc1
  s_waitcnt lgkmcnt(0)
L_fend:
L_end:
  s_endpgm
.p2align 4
.type lane_table,@object
lane_table:
  .long 0x0, 0x4800000, 0x4900480, 0x3f80
  .long 0x40002, 0x4840002, 0x4920482, 0x3f800000
  .long 0x80004, 0x4880060, 0x4940484, 0x3f80
  .long 0xc0006, 0x48c0062, 0x4960486, 0x3f800000
  .long 0x100008, 0xffff0004, 0x4980488, 0x0
  .long 0x14000a, 0xffff0006, 0x49a048a, 0x0
  .long 0x18000c, 0xffff0064, 0x49c048c, 0x0
  .long 0x1c000e, 0xffff0066, 0x49e048e, 0x0
  .long 0x200020, 0xffff0008, 0xffffffff, 0x0
  .long 0x240022, 0xffff000a, 0xffffffff, 0x0
  .long 0x280024, 0xffff0068, 0xffffffff, 0x0
  .long 0x2c0026, 0xffff006a, 0xffffffff, 0x0
  .long 0x300028, 0xffff000c, 0xffffffff, 0x0
  .long 0x34002a, 0xffff000e, 0xffffffff, 0x0
  .long 0x38002c, 0xffff006c, 0xffffffff, 0x0
  .long 0x3c002e, 0xffff006e, 0xffffffff, 0x0
  .long 0x600000, 0xffff0010, 0x4b004a0, 0x0
  .long 0x640002, 0xffff0012, 0x4b204a2, 0x0
  .long 0x680004, 0xffff0070, 0x4b404a4, 0x0
  .long 0x6c0006, 0xffff0072, 0x4b604a6, 0x0
  .long 0x700008, 0x4900014, 0x4b804a8, 0x3f80
  .long 0x74000a, 0x4940016, 0x4ba04aa, 0x3f800000
  .long 0x78000c, 0x4980074, 0x4bc04ac, 0x3f80
  .long 0x7c000e, 0x49c0076, 0x4be04ae, 0x3f800000
  .long 0x400020, 0xffff0018, 0xffffffff, 0x0
  .long 0x440022, 0xffff001a, 0xffffffff, 0x0
  .long 0x480024, 0xffff0078, 0xffffffff, 0x0
  .long 0x4c0026, 0xffff007a, 0xffffffff, 0x0
  .long 0x500028, 0xffff001c, 0xffffffff, 0x0
  .long 0x54002a, 0xffff001e, 0xffffffff, 0x0
  .long 0x58002c, 0xffff007c, 0xffffffff, 0x0
  .long 0x5c002e, 0xffff007e, 0xffffffff, 0x0
  .long 0x800030, 0xffff0020, 0xffffffff, 0x0
  .long 0x840032, 0xffff0022, 0xffffffff, 0x0
  .long 0x880034, 0xffff0040, 0xffffffff, 0x0
  .long 0x8c0036, 0xffff0042, 0xffffffff, 0x0
  .long 0x900038, 0xffff0024, 0xffffffff, 0x0
  .long 0x94003a, 0xffff0026, 0xffffffff, 0x0
  .long 0x98003c, 0xffff0044, 0xffffffff, 0x0
  .long 0x9c003e, 0xffff0046, 0xffffffff, 0x0
  .long 0xa00010, 0x4a00028, 0x4c004d0, 0x3f80
  .long 0xa40012, 0x4a4002a, 0x4c204d2, 0x3f800000
  .long 0xa80014, 0x4a80048, 0x4c404d4, 0x3f80
  .long 0xac0016, 0x4ac004a, 0x4c604d6, 0x3f800000
  .long 0xb00018, 0xffff002c, 0x4c804d8, 0x0
  .long 0xb4001a, 0xffff002e, 0x4ca04da, 0x0
  .long 0xb8001c, 0xffff004c, 0x4cc04dc, 0x0
  .long 0xbc001e, 0xffff004e, 0x4ce04de, 0x0
  .long 0xe00030, 0xffff0030, 0xffffffff, 0x0
  .long 0xe40032, 0xffff0032, 0xffffffff, 0x0
  .long 0xe80034, 0xffff0050, 0xffffffff, 0x0
  .long 0xec0036, 0xffff0052, 0xffffffff, 0x0
  .long 0xf00038, 0xffff0034, 0xffffffff, 0x0
  .long 0xf4003a, 0xffff0036, 0xffffffff, 0x0
  .long 0xf8003c, 0xffff0054, 0xffffffff, 0x0
  .long 0xfc003e, 0xffff0056, 0xffffffff, 0x0
  .long 0xc00010, 0xffff0038, 0x4e004f0, 0x0
  .long 0xc40012, 0xffff003a, 0x4e204f2, 0x0
  .long 0xc80014, 0xffff0058, 0x4e404f4, 0x0
  .long 0xcc0016, 0xffff005a, 0x4e604f6, 0x0
  .long 0xd00018, 0x4b0003c, 0x4e804f8, 0x3f80
  .long 0xd4001a, 0x4b4003e, 0x4ea04fa, 0x3f800000
  .long 0xd8001c, 0x4b8005c, 0x4ec04fc, 0x3f80
  .long 0xdc001e, 0x4bc005e, 0x4ee04fe, 0x3f800000
  .long 0x4820480, 0x40000, 0x0, 0x0
  .long 0x4870484, 0xffff0001, 0x240010, 0x10004
  .long 0x48a0488, 0x140002, 0x480020, 0x20008
  .long 0x48f048c, 0xffff0003, 0x6c0030, 0x3000c
  .long 0x4920490, 0x240008, 0x900040, 0x40010
  .long 0x4970494, 0xffff0009, 0xb40050, 0x50014
  .long 0x49a0498, 0x34000a, 0xd80060, 0x60018
  .long 0x49f049c, 0xffff000b, 0xfc0070, 0x7001c
  .long 0x4a204a0, 0x440010, 0x1200080, 0x80024
  .long 0x4a704a4, 0xffff0011, 0x1440090, 0x90028
  .long 0x4aa04a8, 0x540012, 0x16800a0, 0xa002c
  .long 0x4af04ac, 0xffff0013, 0x18c00b0, 0xb0030
  .long 0x4b204b0, 0x640018, 0x1b000c0, 0xc0034
  .long 0x4b704b4, 0xffff0019, 0x1d400d0, 0xd0038
  .long 0x4ba04b8, 0x74001a, 0xffff00e0, 0xe003c
  .long 0x4bf04bc, 0xffff001b, 0xffff00f0, 0xf0040
  .long 0x4e204e0, 0x80024, 0x20000, 0x800048
  .long 0x4e704e4, 0xffff0025, 0x260010, 0x81004c
  .long 0x4ea04e8, 0x180026, 0x4a0020, 0x820050
  .long 0x4ef04ec, 0xffff0027, 0x6e0030, 0x830054
  .long 0x4f204f0, 0x28002c, 0x920040, 0x840058
  .long 0x4f704f4, 0xffff002d, 0xb60050, 0x85005c
  .long 0x4fa04f8, 0x38002e, 0xda0060, 0x860060
  .long 0x4ff04fc, 0xffff002f, 0xfe0070, 0x870064
  .long 0x5020500, 0x480034, 0x1220080, 0x88006c
  .long 0x5070504, 0xffff0035, 0x1460090, 0x890070
  .long 0x50a0508, 0x580036, 0x16a00a0, 0x8a0074
  .long 0x50f050c, 0xffff0037, 0x18e00b0, 0x8b0078
  .long 0x5120510, 0x68003c, 0x1b200c0, 0x8c007c
  .long 0x5170514, 0xffff003d, 0x1d600d0, 0x8d0080
  .long 0x51a0518, 0x78003e, 0xffff00e0, 0x8e0084
  .long 0x51f051c, 0xffff003f, 0xffff00f0, 0x8f0088
  .long 0x5420540, 0xffff0040, 0x40000, 0x1000090
  .long 0x5470544, 0xc0041, 0x280010, 0x1010094
  .long 0x54a0548, 0xffff0042, 0x4c0020, 0x1020098
  .long 0x54f054c, 0x1c0043, 0x700030, 0x103009c
  .long 0x5520550, 0xffff0048, 0x940040, 0x10400a0
  .long 0x5570554, 0x2c0049, 0xb80050, 0x10500a4
  .long 0x55a0558, 0xffff004a, 0xdc0060, 0x10600a8
  .long 0x55f055c, 0x3c004b, 0x1000070, 0x10700ac
  .long 0x5620560, 0xffff0050, 0x1240080, 0x10800b4
  .long 0x5670564, 0x4c0051, 0x1480090, 0x10900b8
  .long 0x56a0568, 0xffff0052, 0x16c00a0, 0x10a00bc
  .long 0x56f056c, 0x5c0053, 0x19000b0, 0x10b00c0
  .long 0x5720570, 0xffff0058, 0x1b400c0, 0x10c00c4
  .long 0x5770574, 0x6c0059, 0x1d800d0, 0x10d00c8
  .long 0x57a0578, 0xffff005a, 0xffff00e0, 0x10e00cc
  .long 0x57f057c, 0x7c005b, 0xffff00f0, 0x10f00d0
  .long 0x5a205a0, 0xffff0064, 0x60000, 0x18000d8
  .long 0x5a705a4, 0x100065, 0x2a0010, 0x18100dc
  .long 0x5aa05a8, 0xffff0066, 0x4e0020, 0x18200e0
  .long 0x5af05ac, 0x200067, 0x720030, 0x18300e4
  .long 0x5b205b0, 0xffff006c, 0x960040, 0x18400e8
  .long 0x5b705b4, 0x30006d, 0xba0050, 0x18500ec
  .long 0x5ba05b8, 0xffff006e, 0xde0060, 0x18600f0
  .long 0x5bf05bc, 0x40006f, 0x1020070, 0x18700f4
  .long 0x5c205c0, 0xffff0074, 0x1260080, 0x18800fc
  .long 0x5c705c4, 0x500075, 0x14a0090, 0x1890100
  .long 0x5ca05c8, 0xffff0076, 0x16e00a0, 0x18a0104
  .long 0x5cf05cc, 0x600077, 0x19200b0, 0x18b0108
  .long 0x5d205d0, 0xffff007c, 0x1b600c0, 0x18c010c
  .long 0x5d705d4, 0x70007d, 0x1da00d0, 0x18d0110
  .long 0x5da05d8, 0xffff007e, 0xffff00e0, 0x18e0114
  .long 0x5df05dc, 0x80007f, 0xffff00f0, 0x18f0118
.size lane_table, 2048
.section .rodata,"a"
.p2align 6
.amdhsa_kernel standalone__hybrid_graph_tf_nagphormer__graph_kernel
  .amdhsa_next_free_vgpr 128
  .amdhsa_next_free_sgpr 102
  .amdhsa_accum_offset 128
  .amdhsa_group_segment_fixed_size 0
  .amdhsa_kernarg_size 96
  .amdhsa_user_sgpr_count 2
  .amdhsa_user_sgpr_kernarg_segment_ptr 1
  .amdhsa_system_sgpr_workgroup_id_x 1
  .amdhsa_float_denorm_mode_32 3
.end_amdhsa_kernel
```
